```python
import torch

def _softmax(x, axis=-1):
    return torch.softmax(x, dim=axis)
def _gelu(x):
    return torch.nn.functional.gelu(x, approximate="tanh")
def _silu(x):
    return torch.nn.functional.silu(x)
def _sigmoid(x):
    return torch.sigmoid(x)
def _layernorm(x, axis=-1, eps=1e-5):
    m = x.mean(dim=axis, keepdim=True)
    v = x.var(dim=axis, keepdim=True, unbiased=False)
    return (x - m) / torch.sqrt(v + eps)
def _scatter_add(tgt, idx, src, axis=0):
    return tgt.clone().index_add_(axis, idx, src)
def _segment_sum(src, seg, n):
    out = torch.zeros((n,) + src.shape[1:], dtype=src.dtype)
    return out.index_add_(0, seg, src)
def _pad(x, pw):
    flat = tuple(v for pair in reversed(pw) for v in pair)
    return torch.nn.functional.pad(x, flat)

kernel_name = 'concat_heads__linear_attn_block__ssm_conv_s5__prompt'

def setup_inputs():

    _w = (lambda a: (lambda t: t.to(torch.bfloat16) if t.is_floating_point() else t)(torch.as_tensor(a)))
    def _A_setup():
        B, S, D = 1, 2048, 512
        return {
            "x": _w((lambda *s: torch.randn(*s, dtype=torch.bfloat16) * 0.05)(B, S, D)),
            "wqkv": _w((lambda *s: torch.randn(*s, dtype=torch.bfloat16) * 0.4)(D, 3 * D)),
            "wo": _w((lambda *s: torch.randn(*s, dtype=torch.bfloat16) * 0.05)(D, D)),
        }
    _A_in = _A_setup()

    def _B_setup():
        B, S, D = 1, 2048, 512
        P = D
        Lambda_re = -0.5 * (lambda _x: torch.exp(torch.as_tensor(_x)))((lambda *s: torch.randn(*s, dtype=torch.bfloat16) * 0.2)(P))
        Lambda_im = (lambda *s: torch.randn(*s, dtype=torch.bfloat16) * 0.8)(P) * 1.0
        B_re = (lambda *s: torch.randn(*s, dtype=torch.bfloat16) * 0.2)(P, D) * (D ** -0.5)
        B_im = (lambda *s: torch.randn(*s, dtype=torch.bfloat16) * 0.2)(P, D) * (D ** -0.5)
        C_re = (lambda *s: torch.randn(*s, dtype=torch.bfloat16) * 0.2)(D, P) * (P ** -0.5)
        C_im = (lambda *s: torch.randn(*s, dtype=torch.bfloat16) * 0.2)(D, P) * (P ** -0.5)
        log_dt = (lambda *s: torch.randn(*s, dtype=torch.bfloat16) * 0.2)(P) * 0.3 - 2.0
        Dskip = (lambda *s: torch.randn(*s, dtype=torch.bfloat16) * 0.05)(D)
        return {
            "x": _w((lambda *s: torch.randn(*s, dtype=torch.bfloat16) * 0.05)(B, S, D)),
            "Lambda_re": _w(Lambda_re),
            "Lambda_im": _w(Lambda_im),
            "B_re": _w(B_re),
            "B_im": _w(B_im),
            "C_re": _w(C_re),
            "C_im": _w(C_im),
            "log_dt": _w(log_dt),
            "Dskip": _w(Dskip),
        }
    _B_in = _B_setup()

    return {
        "A_x": _A_in["x"],
        "A_wqkv": _A_in["wqkv"],
        "A_wo": _A_in["wo"],
        "B_x": _B_in["x"],
        "B_Lambda_re": _B_in["Lambda_re"],
        "B_Lambda_im": _B_in["Lambda_im"],
        "B_B_re": _B_in["B_re"],
        "B_B_im": _B_in["B_im"],
        "B_C_re": _B_in["C_re"],
        "B_C_im": _B_in["C_im"],
        "B_log_dt": _B_in["log_dt"],
        "B_Dskip": _B_in["Dskip"],
    }

def reference(A_x, A_wqkv, A_wo, B_x, B_Lambda_re, B_Lambda_im, B_B_re, B_B_im, B_C_re, B_C_im, B_log_dt, B_Dskip):
    def _A_ref(x, wqkv, wo):
        B, S, D = x.shape
        H = 32; Dh = D // H
        qkv = (lambda x, *d: x.permute(*d))((x @ wqkv).reshape(B, S, 3, H, Dh), 2, 0, 3, 1, 4)
        q, k, v = qkv[0], qkv[1], qkv[2]
        phi = lambda t: torch.where(t > 0, t + 1, torch.exp(t)) + 1e-6
        pq, pk = phi(q), phi(k)
        kv = torch.einsum("bhsd,bhse->bhde", pk, v)
        z = torch.einsum("bhsd->bhd", pk)
        num = torch.einsum("bhqd,bhde->bhqe", pq, kv)
        den = torch.einsum("bhqd,bhd->bhq", pq, z)[..., None] + 1e-6
        o = num / den
        return (lambda x, *d: x.permute(*d))(o, 0, 2, 1, 3).reshape(B, S, D) @ wo

    def _B_ref(x, Lambda_re, Lambda_im, B_re, B_im, C_re, C_im, log_dt, Dskip):
        Bsz, L, H = x.shape
        Lam = Lambda_re + 1j * Lambda_im
        Bmat = B_re + 1j * B_im
        Cmat = C_re + 1j * C_im
        dt = torch.exp(log_dt)
        Lam_bar = torch.exp(dt * Lam)
        B_bar = ((Lam_bar - 1.0) / Lam)[:, None] * Bmat
        Bu = torch.einsum("bld,pd->blp", x + 0j, B_bar)
        h = torch.zeros_like(Bu[:, 0, :])
        hs = []
        for t in range(L):
            h = Lam_bar[None, :] * h + Bu[:, t, :]
            hs.append(h)
        hseq = torch.stack(hs, 1)
        y = 2.0 * torch.einsum("blp,dp->bld", hseq, Cmat).real + x * Dskip[None, None, :]
        return y

    a = _A_ref(A_x, A_wqkv, A_wo)
    b = _B_ref(B_x, B_Lambda_re, B_Lambda_im, B_B_re, B_B_im, B_C_re, B_C_im, B_log_dt, B_Dskip)
    return torch.concatenate([a, b], axis=-1)
```

```asm
; @launch grid=(256,1,1) block=(512,1,1) lds=163840
.amdgcn_target "amdgcn-amd-amdhsa--gfx950"
.text
.globl concat_heads__linear_attn_block__ssm_conv_s5__prompt_kernel
.p2align 8
.type concat_heads__linear_attn_block__ssm_conv_s5__prompt_kernel,@function
concat_heads__linear_attn_block__ssm_conv_s5__prompt_kernel:
    s_cmp_ge_u32 s2, 256
    s_cbranch_scc1 L_exit
    s_load_dwordx16 s[16:31], s[0:1], 0
    s_load_dwordx8 s[32:39], s[0:1], 64
    s_load_dwordx4 s[40:43], s[0:1], 96
    s_load_dwordx2 s[44:45], s[0:1], 112
    s_and_b32 s4, s2, 7
    s_lshr_b32 s5, s2, 3
    s_lshr_b32 s6, s4, 1
    s_and_b32 s8, s4, 1
    s_lshl_b32 s6, s6, 2
    s_lshr_b32 s76, s5, 3
    s_add_u32 s6, s6, s76
    s_and_b32 s7, s5, 7
    s_cmp_ge_u32 s5, 2
    s_cbranch_scc1 L_nocpf
    s_getpc_b64 s[12:13]
L_pc:
    s_sub_u32 s12, s12, L_pc-concat_heads__linear_attn_block__ssm_conv_s5__prompt_kernel
    s_subb_u32 s13, s13, 0
    v_lshlrev_b32 v2, 7, v0
    v_cmp_gt_u32 vcc, L_code_end-concat_heads__linear_attn_block__ssm_conv_s5__prompt_kernel, v2
    s_nop 0
    s_and_saveexec_b64 s[14:15], vcc
    s_cbranch_execz L_nocpf2
    global_load_dword v255, v2, s[12:13]
L_nocpf2:
    s_mov_b64 exec, s[14:15]
L_nocpf:
    v_lshrrev_b32 v1, 6, v0
    v_and_b32 v0, 63, v0
    v_readfirstlane_b32 s9, v1
    s_mov_b32 s3, 0
    s_and_b32 s10, s9, 3
    s_cmp_ge_u32 s9, 4
    s_cbranch_scc1 L_loaders
    s_cmp_eq_u32 s8, 0
    s_cbranch_scc1 L_computeA
    s_branch L_computeB
L_loaders:
    s_cmp_eq_u32 s8, 0
    s_cbranch_scc1 L_loaderA
L_loaderB:
    v_lshrrev_b32 v7, 3, v0
    v_and_b32 v8, 7, v0
    v_xor_b32 v9, v8, v7
    v_lshlrev_b32 v9, 4, v9
    v_lshl_add_u32 v2, v7, 13, v9
    v_bfe_u32 v9, v0, 5, 1
    v_lshlrev_b32 v9, 1, v9
    v_xor_b32 v9, v8, v9
    v_lshlrev_b32 v9, 4, v9
    v_lshl_add_u32 v3, v7, 10, v9
    v_xor_b32 v4, 64, v3
    v_xor_b32 v5, 16, v3
    v_xor_b32 v6, 80, v3
    v_lshlrev_b32 v14, 4, v0
    s_lshl_b32 s11, s6, 17
    s_lshl_b32 s76, s10, 11
    s_add_u32 s11, s11, s76
    s_lshl_b32 s12, s10, 12
    s_lshl_b32 s13, s7, 16
    s_lshl_b32 s76, s10, 14
    s_add_u32 s13, s13, s76
    s_and_b32 s76, s6, 3
    s_lshl_b32 s76, s76, 1
    s_add_u32 s76, s76, s7
    s_add_u32 s77, s76, 0
    s_and_b32 s77, s77, 7
    s_lshl_b32 s80, s77, 7
    s_add_u32 s77, s76, 1
    s_and_b32 s77, s77, 7
    s_lshl_b32 s81, s77, 7
    s_add_u32 s77, s76, 2
    s_and_b32 s77, s77, 7
    s_lshl_b32 s82, s77, 7
    s_add_u32 s77, s76, 3
    s_and_b32 s77, s77, 7
    s_lshl_b32 s83, s77, 7
    s_add_u32 s77, s76, 4
    s_and_b32 s77, s77, 7
    s_lshl_b32 s84, s77, 7
    s_add_u32 s77, s76, 5
    s_and_b32 s77, s77, 7
    s_lshl_b32 s85, s77, 7
    s_add_u32 s77, s76, 6
    s_and_b32 s77, s77, 7
    s_lshl_b32 s86, s77, 7
    s_add_u32 s77, s76, 7
    s_and_b32 s77, s77, 7
    s_lshl_b32 s87, s77, 7
    s_waitcnt lgkmcnt(0)
    s_mov_b32 s48, s22
    s_mov_b32 s49, s23
    s_mov_b32 s50, 0x200000
    s_mov_b32 s51, 0x00020000
    s_mov_b32 s52, s28
    s_mov_b32 s53, s29
    s_mov_b32 s54, 0x80000
    s_mov_b32 s55, 0x00020000
    s_mov_b32 s56, s30
    s_mov_b32 s57, s31
    s_mov_b32 s58, 0x80000
    s_mov_b32 s59, 0x00020000
    s_mov_b32 s60, s32
    s_mov_b32 s61, s33
    s_mov_b32 s62, 0x80000
    s_mov_b32 s63, 0x00020000
    s_mov_b32 s64, s34
    s_mov_b32 s65, s35
    s_mov_b32 s66, 0x80000
    s_mov_b32 s67, 0x00020000
    s_mov_b32 s68, s44
    s_mov_b32 s69, s45
    s_mov_b32 s70, 0x1000000
    s_mov_b32 s71, 0x00020000
    s_lshl_b32 s14, s7, 16
    s_lshl_b32 s76, s10, 12
    s_add_u32 s14, s14, s76
    s_lshl_b32 s15, s10, 13
    s_add_u32 s78, s11, s80
    s_add_u32 m0, s12, 0x0
    s_add_u32 s79, s78, 0x0
    buffer_load_dwordx4 v2, s[48:51], s79 offen lds
    s_add_u32 m0, s12, 0x400
    s_add_u32 s79, s78, 0x10000
    buffer_load_dwordx4 v2, s[48:51], s79 offen lds
    s_add_u32 m0, s12, 0x800
    s_add_u32 s79, s78, 0x400
    buffer_load_dwordx4 v2, s[48:51], s79 offen lds
    s_add_u32 m0, s12, 0xc00
    s_add_u32 s79, s78, 0x10400
    buffer_load_dwordx4 v2, s[48:51], s79 offen lds
    s_add_u32 s78, s13, s80
    s_add_u32 m0, s12, 0x4000
    s_add_u32 s79, s78, 0x0
    buffer_load_dwordx4 v3, s[52:55], s79 offen lds
    s_add_u32 m0, s12, 0x4400
    s_add_u32 s79, s78, 0x2000
    buffer_load_dwordx4 v4, s[52:55], s79 offen lds
    s_add_u32 m0, s12, 0x4800
    s_add_u32 s79, s78, 0x0
    buffer_load_dwordx4 v5, s[56:59], s79 offen lds
    s_add_u32 m0, s12, 0x4c00
    s_add_u32 s79, s78, 0x2000
    buffer_load_dwordx4 v6, s[56:59], s79 offen lds
    s_add_u32 s78, s11, s81
    s_add_u32 m0, s12, 0x8000
    s_add_u32 s79, s78, 0x0
    buffer_load_dwordx4 v2, s[48:51], s79 offen lds
    s_add_u32 m0, s12, 0x8400
    s_add_u32 s79, s78, 0x10000
    buffer_load_dwordx4 v2, s[48:51], s79 offen lds
    s_add_u32 m0, s12, 0x8800
    s_add_u32 s79, s78, 0x400
    buffer_load_dwordx4 v2, s[48:51], s79 offen lds
    s_add_u32 m0, s12, 0x8c00
    s_add_u32 s79, s78, 0x10400
    buffer_load_dwordx4 v2, s[48:51], s79 offen lds
    s_add_u32 s78, s13, s81
    s_add_u32 m0, s12, 0xc000
    s_add_u32 s79, s78, 0x0
    buffer_load_dwordx4 v3, s[52:55], s79 offen lds
    s_add_u32 m0, s12, 0xc400
    s_add_u32 s79, s78, 0x2000
    buffer_load_dwordx4 v4, s[52:55], s79 offen lds
    s_add_u32 m0, s12, 0xc800
    s_add_u32 s79, s78, 0x0
    buffer_load_dwordx4 v5, s[56:59], s79 offen lds
    s_add_u32 m0, s12, 0xcc00
    s_add_u32 s79, s78, 0x2000
    buffer_load_dwordx4 v6, s[56:59], s79 offen lds
    s_load_dwordx2 s[46:47], s[44:45], 0
    s_branch L_ldB_tail
L_loaderA:
    v_lshrrev_b32 v7, 3, v0
    v_and_b32 v8, 7, v0
    v_xor_b32 v9, v8, v7
    v_lshlrev_b32 v9, 4, v9
    v_lshl_add_u32 v2, v7, 10, v9
    v_bfe_u32 v9, v0, 4, 1
    v_lshlrev_b32 v9, 1, v9
    v_xor_b32 v9, v8, v9
    v_lshlrev_b32 v9, 4, v9
    v_mul_u32_u24 v3, 3072, v7
    v_add_u32 v3, v3, v9
    v_xor_b32 v4, 64, v3
    v_and_b32 v9, 6, v7
    v_xor_b32 v9, v8, v9
    v_lshlrev_b32 v9, 4, v9
    v_lshl_add_u32 v5, v7, 10, v9
    v_mov_b32 v6, v5
    s_lshl_b32 s11, s6, 17
    s_lshl_b32 s76, s10, 15
    s_add_u32 s11, s11, s76
    s_lshl_b32 s12, s10, 12
    s_and_b32 s76, s10, 1
    s_mul_i32 s13, s76, 98304
    s_lshr_b32 s76, s10, 1
    s_add_u32 s76, s76, 1
    s_lshl_b32 s76, s76, 10
    s_add_u32 s13, s13, s76
    s_lshl_b32 s76, s7, 7
    s_add_u32 s13, s13, s76
    s_mul_i32 s14, s10, 49152
    s_add_u32 s14, s14, s76
    s_lshl_b32 s15, s10, 11
    s_and_b32 s76, s6, 3
    s_lshl_b32 s76, s76, 1
    s_add_u32 s76, s76, s7
    s_add_u32 s77, s76, 0
    s_and_b32 s77, s77, 7
    s_lshl_b32 s80, s77, 7
    s_mul_i32 s88, s77, 196608
    s_add_u32 s77, s76, 1
    s_and_b32 s77, s77, 7
    s_lshl_b32 s81, s77, 7
    s_mul_i32 s89, s77, 196608
    s_add_u32 s77, s76, 2
    s_and_b32 s77, s77, 7
    s_lshl_b32 s82, s77, 7
    s_mul_i32 s90, s77, 196608
    s_add_u32 s77, s76, 3
    s_and_b32 s77, s77, 7
    s_lshl_b32 s83, s77, 7
    s_mul_i32 s91, s77, 196608
    s_add_u32 s77, s76, 4
    s_and_b32 s77, s77, 7
    s_lshl_b32 s84, s77, 7
    s_mul_i32 s92, s77, 196608
    s_add_u32 s77, s76, 5
    s_and_b32 s77, s77, 7
    s_lshl_b32 s85, s77, 7
    s_mul_i32 s93, s77, 196608
    s_add_u32 s77, s76, 6
    s_and_b32 s77, s77, 7
    s_lshl_b32 s86, s77, 7
    s_mul_i32 s94, s77, 196608
    s_add_u32 s77, s76, 7
    s_and_b32 s77, s77, 7
    s_lshl_b32 s87, s77, 7
    s_mul_i32 s95, s77, 196608
    s_waitcnt lgkmcnt(0)
    s_mov_b32 s48, s16
    s_mov_b32 s49, s17
    s_mov_b32 s50, 0x200000
    s_mov_b32 s51, 0x00020000
    s_mov_b32 s52, s18
    s_mov_b32 s53, s19
    s_mov_b32 s54, 0x180000
    s_mov_b32 s55, 0x00020000
    s_mov_b32 s56, s20
    s_mov_b32 s57, s21
    s_mov_b32 s58, 0x80000
    s_mov_b32 s59, 0x00020000
    s_mov_b32 s68, s44
    s_mov_b32 s69, s45
    s_mov_b32 s70, 0x1000000
    s_mov_b32 s71, 0x00020000
    s_add_u32 s78, s11, s80
    s_add_u32 m0, s12, 0x10000
    s_add_u32 s79, s78, 0x0
    buffer_load_dwordx4 v2, s[48:51], s79 offen lds
    s_add_u32 m0, s12, 0x10400
    s_add_u32 s79, s78, 0x2000
    buffer_load_dwordx4 v2, s[48:51], s79 offen lds
    s_add_u32 m0, s12, 0x10800
    s_add_u32 s79, s78, 0x4000
    buffer_load_dwordx4 v2, s[48:51], s79 offen lds
    s_add_u32 m0, s12, 0x10c00
    s_add_u32 s79, s78, 0x6000
    buffer_load_dwordx4 v2, s[48:51], s79 offen lds
    s_add_u32 s78, s13, s88
    s_add_u32 m0, s12, 0x14000
    s_add_u32 s79, s78, 0x0
    buffer_load_dwordx4 v3, s[52:55], s79 offen lds
    s_add_u32 m0, s12, 0x14400
    s_add_u32 s79, s78, 0x6000
    buffer_load_dwordx4 v4, s[52:55], s79 offen lds
    s_add_u32 m0, s12, 0x14800
    s_add_u32 s79, s78, 0xc000
    buffer_load_dwordx4 v3, s[52:55], s79 offen lds
    s_add_u32 m0, s12, 0x14c00
    s_add_u32 s79, s78, 0x12000
    buffer_load_dwordx4 v4, s[52:55], s79 offen lds
    s_add_u32 s78, s11, s81
    s_add_u32 m0, s12, 0x18000
    s_add_u32 s79, s78, 0x0
    buffer_load_dwordx4 v2, s[48:51], s79 offen lds
    s_add_u32 m0, s12, 0x18400
    s_add_u32 s79, s78, 0x2000
    buffer_load_dwordx4 v2, s[48:51], s79 offen lds
    s_add_u32 m0, s12, 0x18800
    s_add_u32 s79, s78, 0x4000
    buffer_load_dwordx4 v2, s[48:51], s79 offen lds
    s_add_u32 m0, s12, 0x18c00
    s_add_u32 s79, s78, 0x6000
    buffer_load_dwordx4 v2, s[48:51], s79 offen lds
    s_add_u32 s78, s13, s89
    s_add_u32 m0, s12, 0x1c000
    s_add_u32 s79, s78, 0x0
    buffer_load_dwordx4 v3, s[52:55], s79 offen lds
    s_add_u32 m0, s12, 0x1c400
    s_add_u32 s79, s78, 0x6000
    buffer_load_dwordx4 v4, s[52:55], s79 offen lds
    s_add_u32 m0, s12, 0x1c800
    s_add_u32 s79, s78, 0xc000
    buffer_load_dwordx4 v3, s[52:55], s79 offen lds
    s_add_u32 m0, s12, 0x1cc00
    s_add_u32 s79, s78, 0x12000
    buffer_load_dwordx4 v4, s[52:55], s79 offen lds
    s_load_dwordx2 s[46:47], s[44:45], 0
    s_waitcnt vmcnt(8)
    s_waitcnt lgkmcnt(0)
    s_add_u32 s46, s46, 1
    s_addc_u32 s47, s47, 0
    s_barrier
    s_add_u32 s78, s11, s82
    s_add_u32 m0, s12, 0x20000
    s_add_u32 s79, s78, 0x0
    buffer_load_dwordx4 v2, s[48:51], s79 offen lds
    s_add_u32 m0, s12, 0x20400
    s_add_u32 s79, s78, 0x2000
    buffer_load_dwordx4 v2, s[48:51], s79 offen lds
    s_add_u32 m0, s12, 0x20800
    s_add_u32 s79, s78, 0x4000
    buffer_load_dwordx4 v2, s[48:51], s79 offen lds
    s_add_u32 m0, s12, 0x20c00
    s_add_u32 s79, s78, 0x6000
    buffer_load_dwordx4 v2, s[48:51], s79 offen lds
    s_add_u32 s78, s13, s90
    s_add_u32 m0, s12, 0x24000
    s_add_u32 s79, s78, 0x0
    buffer_load_dwordx4 v3, s[52:55], s79 offen lds
    s_add_u32 m0, s12, 0x24400
    s_add_u32 s79, s78, 0x6000
    buffer_load_dwordx4 v4, s[52:55], s79 offen lds
    s_add_u32 m0, s12, 0x24800
    s_add_u32 s79, s78, 0xc000
    buffer_load_dwordx4 v3, s[52:55], s79 offen lds
    s_add_u32 m0, s12, 0x24c00
    s_add_u32 s79, s78, 0x12000
    buffer_load_dwordx4 v4, s[52:55], s79 offen lds
    s_waitcnt vmcnt(8)
    s_barrier
    s_add_u32 s78, s11, s83
    s_add_u32 m0, s12, 0x10000
    s_add_u32 s79, s78, 0x0
    buffer_load_dwordx4 v2, s[48:51], s79 offen lds
    s_add_u32 m0, s12, 0x10400
    s_add_u32 s79, s78, 0x2000
    buffer_load_dwordx4 v2, s[48:51], s79 offen lds
    s_add_u32 m0, s12, 0x10800
    s_add_u32 s79, s78, 0x4000
    buffer_load_dwordx4 v2, s[48:51], s79 offen lds
    s_add_u32 m0, s12, 0x10c00
    s_add_u32 s79, s78, 0x6000
    buffer_load_dwordx4 v2, s[48:51], s79 offen lds
    s_add_u32 s78, s13, s91
    s_add_u32 m0, s12, 0x14000
    s_add_u32 s79, s78, 0x0
    buffer_load_dwordx4 v3, s[52:55], s79 offen lds
    s_add_u32 m0, s12, 0x14400
    s_add_u32 s79, s78, 0x6000
    buffer_load_dwordx4 v4, s[52:55], s79 offen lds
    s_add_u32 m0, s12, 0x14800
    s_add_u32 s79, s78, 0xc000
    buffer_load_dwordx4 v3, s[52:55], s79 offen lds
    s_add_u32 m0, s12, 0x14c00
    s_add_u32 s79, s78, 0x12000
    buffer_load_dwordx4 v4, s[52:55], s79 offen lds
    s_waitcnt vmcnt(8)
    s_barrier
    s_add_u32 s78, s11, s84
    s_add_u32 m0, s12, 0x0
    s_add_u32 s79, s78, 0x0
    buffer_load_dwordx4 v2, s[48:51], s79 offen lds
    s_add_u32 m0, s12, 0x400
    s_add_u32 s79, s78, 0x2000
    buffer_load_dwordx4 v2, s[48:51], s79 offen lds
    s_add_u32 m0, s12, 0x800
    s_add_u32 s79, s78, 0x4000
    buffer_load_dwordx4 v2, s[48:51], s79 offen lds
    s_add_u32 m0, s12, 0xc00
    s_add_u32 s79, s78, 0x6000
    buffer_load_dwordx4 v2, s[48:51], s79 offen lds
    s_add_u32 s78, s13, s92
    s_add_u32 m0, s12, 0x18000
    s_add_u32 s79, s78, 0x0
    buffer_load_dwordx4 v3, s[52:55], s79 offen lds
    s_add_u32 m0, s12, 0x18400
    s_add_u32 s79, s78, 0x6000
    buffer_load_dwordx4 v4, s[52:55], s79 offen lds
    s_add_u32 m0, s12, 0x18800
    s_add_u32 s79, s78, 0xc000
    buffer_load_dwordx4 v3, s[52:55], s79 offen lds
    s_add_u32 m0, s12, 0x18c00
    s_add_u32 s79, s78, 0x12000
    buffer_load_dwordx4 v4, s[52:55], s79 offen lds
    s_add_u32 s78, s11, s85
    s_add_u32 m0, s12, 0x4000
    s_add_u32 s79, s78, 0x0
    buffer_load_dwordx4 v2, s[48:51], s79 offen lds
    s_add_u32 m0, s12, 0x4400
    s_add_u32 s79, s78, 0x2000
    buffer_load_dwordx4 v2, s[48:51], s79 offen lds
    s_add_u32 m0, s12, 0x4800
    s_add_u32 s79, s78, 0x4000
    buffer_load_dwordx4 v2, s[48:51], s79 offen lds
    s_add_u32 m0, s12, 0x4c00
    s_add_u32 s79, s78, 0x6000
    buffer_load_dwordx4 v2, s[48:51], s79 offen lds
    s_add_u32 s78, s13, s93
    s_add_u32 m0, s12, 0x1c000
    s_add_u32 s79, s78, 0x0
    buffer_load_dwordx4 v3, s[52:55], s79 offen lds
    s_add_u32 m0, s12, 0x1c400
    s_add_u32 s79, s78, 0x6000
    buffer_load_dwordx4 v4, s[52:55], s79 offen lds
    s_add_u32 m0, s12, 0x1c800
    s_add_u32 s79, s78, 0xc000
    buffer_load_dwordx4 v3, s[52:55], s79 offen lds
    s_add_u32 m0, s12, 0x1cc00
    s_add_u32 s79, s78, 0x12000
    buffer_load_dwordx4 v4, s[52:55], s79 offen lds
    s_waitcnt vmcnt(16)
    s_barrier
    s_add_u32 s78, s11, s86
    s_add_u32 m0, s12, 0x8000
    s_add_u32 s79, s78, 0x0
    buffer_load_dwordx4 v2, s[48:51], s79 offen lds
    s_add_u32 m0, s12, 0x8400
    s_add_u32 s79, s78, 0x2000
    buffer_load_dwordx4 v2, s[48:51], s79 offen lds
    s_add_u32 m0, s12, 0x8800
    s_add_u32 s79, s78, 0x4000
    buffer_load_dwordx4 v2, s[48:51], s79 offen lds
    s_add_u32 m0, s12, 0x8c00
    s_add_u32 s79, s78, 0x6000
    buffer_load_dwordx4 v2, s[48:51], s79 offen lds
    s_add_u32 s78, s13, s94
    s_add_u32 m0, s12, 0x20000
    s_add_u32 s79, s78, 0x0
    buffer_load_dwordx4 v3, s[52:55], s79 offen lds
    s_add_u32 m0, s12, 0x20400
    s_add_u32 s79, s78, 0x6000
    buffer_load_dwordx4 v4, s[52:55], s79 offen lds
    s_add_u32 m0, s12, 0x20800
    s_add_u32 s79, s78, 0xc000
    buffer_load_dwordx4 v3, s[52:55], s79 offen lds
    s_add_u32 m0, s12, 0x20c00
    s_add_u32 s79, s78, 0x12000
    buffer_load_dwordx4 v4, s[52:55], s79 offen lds
    s_add_u32 s78, s11, s87
    s_add_u32 m0, s12, 0xc000
    s_add_u32 s79, s78, 0x0
    buffer_load_dwordx4 v2, s[48:51], s79 offen lds
    s_add_u32 m0, s12, 0xc400
    s_add_u32 s79, s78, 0x2000
    buffer_load_dwordx4 v2, s[48:51], s79 offen lds
    s_add_u32 m0, s12, 0xc800
    s_add_u32 s79, s78, 0x4000
    buffer_load_dwordx4 v2, s[48:51], s79 offen lds
    s_add_u32 m0, s12, 0xcc00
    s_add_u32 s79, s78, 0x6000
    buffer_load_dwordx4 v2, s[48:51], s79 offen lds
    s_add_u32 s78, s13, s95
    s_add_u32 m0, s12, 0x24000
    s_add_u32 s79, s78, 0x0
    buffer_load_dwordx4 v3, s[52:55], s79 offen lds
    s_add_u32 m0, s12, 0x24400
    s_add_u32 s79, s78, 0x6000
    buffer_load_dwordx4 v4, s[52:55], s79 offen lds
    s_add_u32 m0, s12, 0x24800
    s_add_u32 s79, s78, 0xc000
    buffer_load_dwordx4 v3, s[52:55], s79 offen lds
    s_add_u32 m0, s12, 0x24c00
    s_add_u32 s79, s78, 0x12000
    buffer_load_dwordx4 v4, s[52:55], s79 offen lds
    s_waitcnt vmcnt(24)
    s_barrier
    s_add_u32 s78, s14, s92
    s_add_u32 m0, s15, 0x10000
    s_add_u32 s79, s78, 0x0
    buffer_load_dwordx4 v3, s[52:55], s79 offen lds
    s_add_u32 m0, s15, 0x10400
    s_add_u32 s79, s78, 0x6000
    buffer_load_dwordx4 v4, s[52:55], s79 offen lds
    s_add_u32 s78, s14, s93
    s_add_u32 m0, s15, 0x12000
    s_add_u32 s79, s78, 0x0
    buffer_load_dwordx4 v3, s[52:55], s79 offen lds
    s_add_u32 m0, s15, 0x12400
    s_add_u32 s79, s78, 0x6000
    buffer_load_dwordx4 v4, s[52:55], s79 offen lds
    s_add_u32 s78, s14, s94
    s_add_u32 m0, s15, 0x14000
    s_add_u32 s79, s78, 0x0
    buffer_load_dwordx4 v3, s[52:55], s79 offen lds
    s_add_u32 m0, s15, 0x14400
    s_add_u32 s79, s78, 0x6000
    buffer_load_dwordx4 v4, s[52:55], s79 offen lds
    s_add_u32 s78, s14, s95
    s_add_u32 m0, s15, 0x16000
    s_add_u32 s79, s78, 0x0
    buffer_load_dwordx4 v3, s[52:55], s79 offen lds
    s_add_u32 m0, s15, 0x16400
    s_add_u32 s79, s78, 0x6000
    buffer_load_dwordx4 v4, s[52:55], s79 offen lds
    s_waitcnt vmcnt(24)
    s_barrier
    s_add_u32 s78, s11, s80
    s_add_u32 m0, s12, 0x18000
    s_add_u32 s79, s78, 0x0
    buffer_load_dwordx4 v2, s[48:51], s79 offen lds
    s_add_u32 m0, s12, 0x18400
    s_add_u32 s79, s78, 0x2000
    buffer_load_dwordx4 v2, s[48:51], s79 offen lds
    s_add_u32 m0, s12, 0x18800
    s_add_u32 s79, s78, 0x4000
    buffer_load_dwordx4 v2, s[48:51], s79 offen lds
    s_add_u32 m0, s12, 0x18c00
    s_add_u32 s79, s78, 0x6000
    buffer_load_dwordx4 v2, s[48:51], s79 offen lds
    s_waitcnt vmcnt(20)
    s_barrier
    s_add_u32 s78, s11, s81
    s_add_u32 m0, s12, 0x1c000
    s_add_u32 s79, s78, 0x0
    buffer_load_dwordx4 v2, s[48:51], s79 offen lds
    s_add_u32 m0, s12, 0x1c400
    s_add_u32 s79, s78, 0x2000
    buffer_load_dwordx4 v2, s[48:51], s79 offen lds
    s_add_u32 m0, s12, 0x1c800
    s_add_u32 s79, s78, 0x4000
    buffer_load_dwordx4 v2, s[48:51], s79 offen lds
    s_add_u32 m0, s12, 0x1cc00
    s_add_u32 s79, s78, 0x6000
    buffer_load_dwordx4 v2, s[48:51], s79 offen lds
    s_waitcnt vmcnt(16)
    s_barrier
    s_add_u32 s78, s11, s82
    s_add_u32 m0, s12, 0x20000
    s_add_u32 s79, s78, 0x0
    buffer_load_dwordx4 v2, s[48:51], s79 offen lds
    s_add_u32 m0, s12, 0x20400
    s_add_u32 s79, s78, 0x2000
    buffer_load_dwordx4 v2, s[48:51], s79 offen lds
    s_add_u32 m0, s12, 0x20800
    s_add_u32 s79, s78, 0x4000
    buffer_load_dwordx4 v2, s[48:51], s79 offen lds
    s_add_u32 m0, s12, 0x20c00
    s_add_u32 s79, s78, 0x6000
    buffer_load_dwordx4 v2, s[48:51], s79 offen lds
    v_lshlrev_b32 v21, 7, v0
    s_mov_b32 s96, s40
    s_mov_b32 s97, s41
    s_mov_b32 s98, 0x800000
    s_mov_b32 s99, 0x00020000
    s_cmp_lg_u32 s10, 0
    s_cbranch_scc1 L_pf0_8_1
    s_mov_b32 s77, 0
    s_and_b32 s77, s77, 1
    s_lshl_b32 s77, s77, 13
    s_lshl_b32 s76, s5, 14
    s_add_u32 s76, s76, s77
    buffer_load_dword v20, v21, s[56:59], s76 offen
L_pf0_8_1:
    s_cmp_lg_u32 s10, 1
    s_cbranch_scc1 L_pf0_8_2
    s_mov_b32 s77, 1
    s_and_b32 s77, s77, 1
    s_lshl_b32 s77, s77, 13
    s_lshl_b32 s76, s5, 14
    s_add_u32 s76, s76, s77
    buffer_load_dword v20, v21, s[56:59], s76 offen
L_pf0_8_2:
    s_cmp_lg_u32 s10, 0
    s_cbranch_scc1 L_wx1_0
    s_waitcnt vmcnt(19)
    s_branch L_wx1_done
L_wx1_0:
    s_cmp_lg_u32 s10, 1
    s_cbranch_scc1 L_wx1_1
    s_waitcnt vmcnt(19)
    s_branch L_wx1_done
L_wx1_1:
    s_cmp_lg_u32 s10, 2
    s_cbranch_scc1 L_wx1_2
    s_waitcnt vmcnt(18)
    s_branch L_wx1_done
L_wx1_2:
    s_waitcnt vmcnt(18)
L_wx1_done:
    s_barrier
    s_add_u32 s78, s11, s83
    s_add_u32 m0, s12, 0x24000
    s_add_u32 s79, s78, 0x0
    buffer_load_dwordx4 v2, s[48:51], s79 offen lds
    s_add_u32 m0, s12, 0x24400
    s_add_u32 s79, s78, 0x2000
    buffer_load_dwordx4 v2, s[48:51], s79 offen lds
    s_add_u32 m0, s12, 0x24800
    s_add_u32 s79, s78, 0x4000
    buffer_load_dwordx4 v2, s[48:51], s79 offen lds
    s_add_u32 m0, s12, 0x24c00
    s_add_u32 s79, s78, 0x6000
    buffer_load_dwordx4 v2, s[48:51], s79 offen lds
    s_cmp_lg_u32 s10, 0
    s_cbranch_scc1 L_wx2_0
    s_waitcnt vmcnt(21)
    s_branch L_wx2_done
L_wx2_0:
    s_cmp_lg_u32 s10, 1
    s_cbranch_scc1 L_wx2_1
    s_waitcnt vmcnt(21)
    s_branch L_wx2_done
L_wx2_1:
    s_cmp_lg_u32 s10, 2
    s_cbranch_scc1 L_wx2_2
    s_waitcnt vmcnt(20)
    s_branch L_wx2_done
L_wx2_2:
    s_waitcnt vmcnt(20)
L_wx2_done:
    s_barrier
    s_add_u32 s78, s14, s88
    s_add_u32 m0, s15, 0x10000
    s_add_u32 s79, s78, 0x0
    buffer_load_dwordx4 v3, s[52:55], s79 offen lds
    s_add_u32 m0, s15, 0x10400
    s_add_u32 s79, s78, 0x6000
    buffer_load_dwordx4 v4, s[52:55], s79 offen lds
    s_cmp_lg_u32 s10, 0
    s_cbranch_scc1 L_wx3_0
    s_waitcnt vmcnt(21)
    s_branch L_wx3_done
L_wx3_0:
    s_cmp_lg_u32 s10, 1
    s_cbranch_scc1 L_wx3_1
    s_waitcnt vmcnt(21)
    s_branch L_wx3_done
L_wx3_1:
    s_cmp_lg_u32 s10, 2
    s_cbranch_scc1 L_wx3_2
    s_waitcnt vmcnt(20)
    s_branch L_wx3_done
L_wx3_2:
    s_waitcnt vmcnt(20)
L_wx3_done:
    s_barrier
    s_add_u32 s78, s14, s89
    s_add_u32 m0, s15, 0x12000
    s_add_u32 s79, s78, 0x0
    buffer_load_dwordx4 v3, s[52:55], s79 offen lds
    s_add_u32 m0, s15, 0x12400
    s_add_u32 s79, s78, 0x6000
    buffer_load_dwordx4 v4, s[52:55], s79 offen lds
    s_cmp_lg_u32 s10, 0
    s_cbranch_scc1 L_pf0_11_1
    s_mov_b32 s77, 0
    s_and_b32 s77, s77, 1
    s_lshl_b32 s76, s6, 4
    s_lshl_b32 s78, s7, 1
    s_add_u32 s76, s76, s78
    s_add_u32 s76, s76, s77
    s_lshl_b32 s76, s76, 13
    s_add_u32 s76, s76, 0x100000
    buffer_load_dword v20, v21, s[68:71], s76 offen
L_pf0_11_1:
    s_cmp_lg_u32 s10, 1
    s_cbranch_scc1 L_pf0_11_2
    s_mov_b32 s77, 1
    s_and_b32 s77, s77, 1
    s_lshl_b32 s76, s6, 4
    s_lshl_b32 s78, s7, 1
    s_add_u32 s76, s76, s78
    s_add_u32 s76, s76, s77
    s_lshl_b32 s76, s76, 13
    s_add_u32 s76, s76, 0x100000
    buffer_load_dword v20, v21, s[68:71], s76 offen
L_pf0_11_2:
    s_cmp_lg_u32 s10, 0
    s_cbranch_scc1 L_pf0_11_3
    s_lshl_b32 s76, s6, 8
    s_add_u32 s76, s76, 0x1000
    buffer_load_dword v20, v21, s[68:71], s76 offen
L_pf0_11_3:
    s_cmp_lg_u32 s10, 0
    s_cbranch_scc1 L_wx4_0
    s_waitcnt vmcnt(23)
    s_branch L_wx4_done
L_wx4_0:
    s_cmp_lg_u32 s10, 1
    s_cbranch_scc1 L_wx4_1
    s_waitcnt vmcnt(22)
    s_branch L_wx4_done
L_wx4_1:
    s_cmp_lg_u32 s10, 2
    s_cbranch_scc1 L_wx4_2
    s_waitcnt vmcnt(20)
    s_branch L_wx4_done
L_wx4_2:
    s_waitcnt vmcnt(20)
L_wx4_done:
    s_barrier
    s_add_u32 s78, s14, s90
    s_add_u32 m0, s15, 0x14000
    s_add_u32 s79, s78, 0x0
    buffer_load_dwordx4 v3, s[52:55], s79 offen lds
    s_add_u32 m0, s15, 0x14400
    s_add_u32 s79, s78, 0x6000
    buffer_load_dwordx4 v4, s[52:55], s79 offen lds
    s_cmp_lg_u32 s10, 0
    s_cbranch_scc1 L_wx5_0
    s_waitcnt vmcnt(6)
    s_branch L_wx5_done
L_wx5_0:
    s_cmp_lg_u32 s10, 1
    s_cbranch_scc1 L_wx5_1
    s_waitcnt vmcnt(5)
    s_branch L_wx5_done
L_wx5_1:
    s_cmp_lg_u32 s10, 2
    s_cbranch_scc1 L_wx5_2
    s_waitcnt vmcnt(4)
    s_branch L_wx5_done
L_wx5_2:
    s_waitcnt vmcnt(4)
L_wx5_done:
    s_barrier
    s_add_u32 s78, s14, s91
    s_add_u32 m0, s15, 0x16000
    s_add_u32 s79, s78, 0x0
    buffer_load_dwordx4 v3, s[52:55], s79 offen lds
    s_add_u32 m0, s15, 0x16400
    s_add_u32 s79, s78, 0x6000
    buffer_load_dwordx4 v4, s[52:55], s79 offen lds
    s_cmp_lg_u32 s10, 0
    s_cbranch_scc1 L_wx6_0
    s_waitcnt vmcnt(6)
    s_branch L_wx6_done
L_wx6_0:
    s_cmp_lg_u32 s10, 1
    s_cbranch_scc1 L_wx6_1
    s_waitcnt vmcnt(5)
    s_branch L_wx6_done
L_wx6_1:
    s_cmp_lg_u32 s10, 2
    s_cbranch_scc1 L_wx6_2
    s_waitcnt vmcnt(4)
    s_branch L_wx6_done
L_wx6_2:
    s_waitcnt vmcnt(4)
L_wx6_done:
    s_barrier
    s_waitcnt vmcnt(0)
    s_barrier
    v_lshlrev_b32 v30, 4, v0
    v_and_b32 v31, 15, v0
    v_lshlrev_b32 v31, 6, v31
    v_lshrrev_b32 v29, 4, v0
    v_lshl_add_u32 v31, v29, 4, v31
    s_lshl_b32 s76, s7, 2
    s_add_u32 s76, s76, s10
    s_lshl_b32 s38, s76, 14
    s_add_u32 s38, s38, 0x40000
    s_lshl_b32 s39, s76, 10
    s_add_u32 s39, s39, 0xc0000
    buffer_load_dwordx4 v[96:99], v31, s[68:71], s39 offen sc1
    s_add_u32 s76, s38, 0
    buffer_load_dwordx4 v[32:35], v30, s[68:71], s76 offen offset:0 sc1
    buffer_load_dwordx4 v[36:39], v30, s[68:71], s76 offen offset:1024 sc1
    buffer_load_dwordx4 v[40:43], v30, s[68:71], s76 offen offset:2048 sc1
    buffer_load_dwordx4 v[44:47], v30, s[68:71], s76 offen offset:3072 sc1
    s_add_u32 s76, s38, 4096
    buffer_load_dwordx4 v[48:51], v30, s[68:71], s76 offen offset:0 sc1
    buffer_load_dwordx4 v[52:55], v30, s[68:71], s76 offen offset:1024 sc1
    buffer_load_dwordx4 v[56:59], v30, s[68:71], s76 offen offset:2048 sc1
    buffer_load_dwordx4 v[60:63], v30, s[68:71], s76 offen offset:3072 sc1
    s_add_u32 s76, s38, 8192
    buffer_load_dwordx4 v[64:67], v30, s[68:71], s76 offen offset:0 sc1
    buffer_load_dwordx4 v[68:71], v30, s[68:71], s76 offen offset:1024 sc1
    buffer_load_dwordx4 v[72:75], v30, s[68:71], s76 offen offset:2048 sc1
    buffer_load_dwordx4 v[76:79], v30, s[68:71], s76 offen offset:3072 sc1
    s_add_u32 s76, s38, 12288
    buffer_load_dwordx4 v[80:83], v30, s[68:71], s76 offen offset:0 sc1
    buffer_load_dwordx4 v[84:87], v30, s[68:71], s76 offen offset:1024 sc1
    buffer_load_dwordx4 v[88:91], v30, s[68:71], s76 offen offset:2048 sc1
    buffer_load_dwordx4 v[92:95], v30, s[68:71], s76 offen offset:3072 sc1
    s_lshl_b32 s40, s10, 17
    s_lshl_b32 s76, s7, 7
    s_add_u32 s40, s40, s76
    s_lshl_b32 s41, s10, 14
    s_add_u32 m0, s41, 0x0
    s_add_u32 s79, s40, 0x0
    buffer_load_dwordx4 v5, s[56:59], s79 offen lds
    s_add_u32 m0, s41, 0x400
    s_add_u32 s79, s40, 0x2000
    buffer_load_dwordx4 v6, s[56:59], s79 offen lds
    s_add_u32 m0, s41, 0x800
    s_add_u32 s79, s40, 0x4000
    buffer_load_dwordx4 v5, s[56:59], s79 offen lds
    s_add_u32 m0, s41, 0xc00
    s_add_u32 s79, s40, 0x6000
    buffer_load_dwordx4 v6, s[56:59], s79 offen lds
    s_add_u32 m0, s41, 0x1000
    s_add_u32 s79, s40, 0x8000
    buffer_load_dwordx4 v5, s[56:59], s79 offen lds
    s_add_u32 m0, s41, 0x1400
    s_add_u32 s79, s40, 0xa000
    buffer_load_dwordx4 v6, s[56:59], s79 offen lds
    s_add_u32 m0, s41, 0x1800
    s_add_u32 s79, s40, 0xc000
    buffer_load_dwordx4 v5, s[56:59], s79 offen lds
    s_add_u32 m0, s41, 0x1c00
    s_add_u32 s79, s40, 0xe000
    buffer_load_dwordx4 v6, s[56:59], s79 offen lds
    s_add_u32 m0, s41, 0x2000
    s_add_u32 s79, s40, 0x10000
    buffer_load_dwordx4 v5, s[56:59], s79 offen lds
    s_add_u32 m0, s41, 0x2400
    s_add_u32 s79, s40, 0x12000
    buffer_load_dwordx4 v6, s[56:59], s79 offen lds
    s_add_u32 m0, s41, 0x2800
    s_add_u32 s79, s40, 0x14000
    buffer_load_dwordx4 v5, s[56:59], s79 offen lds
    s_add_u32 m0, s41, 0x2c00
    s_add_u32 s79, s40, 0x16000
    buffer_load_dwordx4 v6, s[56:59], s79 offen lds
    s_add_u32 m0, s41, 0x3000
    s_add_u32 s79, s40, 0x18000
    buffer_load_dwordx4 v5, s[56:59], s79 offen lds
    s_add_u32 m0, s41, 0x3400
    s_add_u32 s79, s40, 0x1a000
    buffer_load_dwordx4 v6, s[56:59], s79 offen lds
    s_add_u32 m0, s41, 0x3800
    s_add_u32 s79, s40, 0x1c000
    buffer_load_dwordx4 v5, s[56:59], s79 offen lds
    s_add_u32 m0, s41, 0x3c00
    s_add_u32 s79, s40, 0x1e000
    buffer_load_dwordx4 v6, s[56:59], s79 offen lds
    v_and_b32 v104, 15, v0
    v_lshrrev_b32 v105, 4, v0
    v_lshlrev_b32 v105, 2, v105
    v_sub_u32 v104, v104, v105
    v_mov_b32 v105, 0x3f80
    v_mov_b32 v106, 0x3f800000
    v_cmp_eq_u32 vcc, 0, v104
    s_nop 1
    v_cndmask_b32 v100, 0, v105, vcc
    v_cmp_eq_u32 vcc, 1, v104
    s_nop 1
    v_cndmask_b32 v100, v100, v106, vcc
    v_cmp_eq_u32 vcc, 2, v104
    s_nop 1
    v_cndmask_b32 v101, 0, v105, vcc
    v_cmp_eq_u32 vcc, 3, v104
    s_nop 1
    v_cndmask_b32 v101, v101, v106, vcc
    s_mov_b32 s3, 0
    s_waitcnt vmcnt(16)
    s_branch L_ldA_kvchk
L_ldA_kv:
    s_waitcnt vmcnt(0)
L_ldA_kvchk:
    v_cmp_ne_u64 vcc, s[46:47], v[98:99]
    v_cmp_ne_u64 s[76:77], s[46:47], v[34:35]
    s_nop 0
    s_or_b64 vcc, vcc, s[76:77]
    v_cmp_ne_u64 s[76:77], s[46:47], v[38:39]
    s_nop 0
    s_or_b64 vcc, vcc, s[76:77]
    v_cmp_ne_u64 s[76:77], s[46:47], v[42:43]
    s_nop 0
    s_or_b64 vcc, vcc, s[76:77]
    v_cmp_ne_u64 s[76:77], s[46:47], v[46:47]
    s_nop 0
    s_or_b64 vcc, vcc, s[76:77]
    v_cmp_ne_u64 s[76:77], s[46:47], v[50:51]
    s_nop 0
    s_or_b64 vcc, vcc, s[76:77]
    v_cmp_ne_u64 s[76:77], s[46:47], v[54:55]
    s_nop 0
    s_or_b64 vcc, vcc, s[76:77]
    v_cmp_ne_u64 s[76:77], s[46:47], v[58:59]
    s_nop 0
    s_or_b64 vcc, vcc, s[76:77]
    v_cmp_ne_u64 s[76:77], s[46:47], v[62:63]
    s_nop 0
    s_or_b64 vcc, vcc, s[76:77]
    v_cmp_ne_u64 s[76:77], s[46:47], v[66:67]
    s_nop 0
    s_or_b64 vcc, vcc, s[76:77]
    v_cmp_ne_u64 s[76:77], s[46:47], v[70:71]
    s_nop 0
    s_or_b64 vcc, vcc, s[76:77]
    v_cmp_ne_u64 s[76:77], s[46:47], v[74:75]
    s_nop 0
    s_or_b64 vcc, vcc, s[76:77]
    v_cmp_ne_u64 s[76:77], s[46:47], v[78:79]
    s_nop 0
    s_or_b64 vcc, vcc, s[76:77]
    v_cmp_ne_u64 s[76:77], s[46:47], v[82:83]
    s_nop 0
    s_or_b64 vcc, vcc, s[76:77]
    v_cmp_ne_u64 s[76:77], s[46:47], v[86:87]
    s_nop 0
    s_or_b64 vcc, vcc, s[76:77]
    v_cmp_ne_u64 s[76:77], s[46:47], v[90:91]
    s_nop 0
    s_or_b64 vcc, vcc, s[76:77]
    v_cmp_ne_u64 s[76:77], s[46:47], v[94:95]
    s_nop 0
    s_or_b64 vcc, vcc, s[76:77]
    s_cmp_eq_u64 vcc, 0
    s_cbranch_scc1 L_ldA_kvok
    s_add_u32 s3, s3, 1
    s_cmp_ge_u32 s3, 1048576
    s_cbranch_scc1 L_ldA_kvok
    buffer_load_dwordx4 v[96:99], v31, s[68:71], s39 offen sc1
    s_add_u32 s76, s38, 0
    buffer_load_dwordx4 v[32:35], v30, s[68:71], s76 offen offset:0 sc1
    buffer_load_dwordx4 v[36:39], v30, s[68:71], s76 offen offset:1024 sc1
    buffer_load_dwordx4 v[40:43], v30, s[68:71], s76 offen offset:2048 sc1
    buffer_load_dwordx4 v[44:47], v30, s[68:71], s76 offen offset:3072 sc1
    s_add_u32 s76, s38, 4096
    buffer_load_dwordx4 v[48:51], v30, s[68:71], s76 offen offset:0 sc1
    buffer_load_dwordx4 v[52:55], v30, s[68:71], s76 offen offset:1024 sc1
    buffer_load_dwordx4 v[56:59], v30, s[68:71], s76 offen offset:2048 sc1
    buffer_load_dwordx4 v[60:63], v30, s[68:71], s76 offen offset:3072 sc1
    s_add_u32 s76, s38, 8192
    buffer_load_dwordx4 v[64:67], v30, s[68:71], s76 offen offset:0 sc1
    buffer_load_dwordx4 v[68:71], v30, s[68:71], s76 offen offset:1024 sc1
    buffer_load_dwordx4 v[72:75], v30, s[68:71], s76 offen offset:2048 sc1
    buffer_load_dwordx4 v[76:79], v30, s[68:71], s76 offen offset:3072 sc1
    s_add_u32 s76, s38, 12288
    buffer_load_dwordx4 v[80:83], v30, s[68:71], s76 offen offset:0 sc1
    buffer_load_dwordx4 v[84:87], v30, s[68:71], s76 offen offset:1024 sc1
    buffer_load_dwordx4 v[88:91], v30, s[68:71], s76 offen offset:2048 sc1
    buffer_load_dwordx4 v[92:95], v30, s[68:71], s76 offen offset:3072 sc1
    s_branch L_ldA_kv
L_ldA_kvok:
    v_mfma_f32_16x16x16_bf16 v[108:111], v[100:101], v[32:33], 0
    v_mfma_f32_16x16x16_bf16 v[108:111], v[100:101], v[36:37], v[108:111]
    v_mfma_f32_16x16x16_bf16 v[108:111], v[100:101], v[40:41], v[108:111]
    v_mfma_f32_16x16x16_bf16 v[108:111], v[100:101], v[44:45], v[108:111]
    v_mfma_f32_16x16x16_bf16 v[108:111], v[100:101], v[48:49], v[108:111]
    v_mfma_f32_16x16x16_bf16 v[108:111], v[100:101], v[52:53], v[108:111]
    v_mfma_f32_16x16x16_bf16 v[108:111], v[100:101], v[56:57], v[108:111]
    v_mfma_f32_16x16x16_bf16 v[108:111], v[100:101], v[60:61], v[108:111]
    v_mfma_f32_16x16x16_bf16 v[108:111], v[100:101], v[64:65], v[108:111]
    v_mfma_f32_16x16x16_bf16 v[108:111], v[100:101], v[68:69], v[108:111]
    v_mfma_f32_16x16x16_bf16 v[108:111], v[100:101], v[72:73], v[108:111]
    v_mfma_f32_16x16x16_bf16 v[108:111], v[100:101], v[76:77], v[108:111]
    v_mfma_f32_16x16x16_bf16 v[108:111], v[100:101], v[80:81], v[108:111]
    v_mfma_f32_16x16x16_bf16 v[108:111], v[100:101], v[84:85], v[108:111]
    v_mfma_f32_16x16x16_bf16 v[108:111], v[100:101], v[88:89], v[108:111]
    v_mfma_f32_16x16x16_bf16 v[108:111], v[100:101], v[92:93], v[108:111]
    v_lshlrev_b32 v112, 16, v96
    v_and_b32 v113, 0xffff0000, v96
    v_lshlrev_b32 v114, 16, v97
    v_and_b32 v115, 0xffff0000, v97
    v_add_f32_dpp v112, v112, v112 row_ror:8 row_mask:0xf bank_mask:0xf
    v_add_f32_dpp v113, v113, v113 row_ror:8 row_mask:0xf bank_mask:0xf
    v_add_f32_dpp v114, v114, v114 row_ror:8 row_mask:0xf bank_mask:0xf
    v_add_f32_dpp v115, v115, v115 row_ror:8 row_mask:0xf bank_mask:0xf
    v_add_f32_dpp v112, v112, v112 row_ror:4 row_mask:0xf bank_mask:0xf
    v_add_f32_dpp v113, v113, v113 row_ror:4 row_mask:0xf bank_mask:0xf
    v_add_f32_dpp v114, v114, v114 row_ror:4 row_mask:0xf bank_mask:0xf
    v_add_f32_dpp v115, v115, v115 row_ror:4 row_mask:0xf bank_mask:0xf
    v_add_f32_dpp v112, v112, v112 row_ror:2 row_mask:0xf bank_mask:0xf
    v_add_f32_dpp v113, v113, v113 row_ror:2 row_mask:0xf bank_mask:0xf
    v_add_f32_dpp v114, v114, v114 row_ror:2 row_mask:0xf bank_mask:0xf
    v_add_f32_dpp v115, v115, v115 row_ror:2 row_mask:0xf bank_mask:0xf
    v_add_f32_dpp v112, v112, v112 row_ror:1 row_mask:0xf bank_mask:0xf
    v_add_f32_dpp v113, v113, v113 row_ror:1 row_mask:0xf bank_mask:0xf
    v_add_f32_dpp v114, v114, v114 row_ror:1 row_mask:0xf bank_mask:0xf
    v_add_f32_dpp v115, v115, v115 row_ror:1 row_mask:0xf bank_mask:0xf
    v_cvt_pk_bf16_f32 v118, v112, v113
    v_cvt_pk_bf16_f32 v119, v114, v115
    v_cvt_pk_bf16_f32 v116, v108, v109
    v_cvt_pk_bf16_f32 v117, v110, v111
    s_lshl_b32 s76, s10, 10
    s_add_u32 s76, s76, 98304
    v_add_u32 v120, s76, v30
    ds_write_b128 v120, v[116:119]
    s_waitcnt lgkmcnt(0)
    s_barrier
    s_waitcnt vmcnt(0)
    s_cmp_lg_u32 s10, 0
    s_cbranch_scc1 L_ldA_nopoll
    v_and_b32 v10, 31, v0
    v_lshlrev_b32 v10, 3, v10
    s_lshl_b32 s76, s6, 8
    s_add_u32 s76, s76, 0x1000
    s_mov_b32 s77, 0
L_ldA_poll:
    buffer_load_dwordx2 v[12:13], v10, s[68:71], s76 offen sc1
    s_add_u32 s77, s77, 1
    s_waitcnt vmcnt(0)
    v_cmp_ne_u64 vcc, s[46:47], v[12:13]
    s_cmp_ge_u32 s77, 1048576
    s_cbranch_scc1 L_ldA_nopoll
    s_cmp_eq_u64 vcc, 0
    s_cbranch_scc0 L_ldA_poll
L_ldA_nopoll:
    s_barrier
    s_or_b32 s76, s2, s10
    s_cmp_lg_u32 s76, 0
    s_cbranch_scc1 L_ldA_noepoch
    v_lshlrev_b32 v10, 7, v0
    s_mov_b32 s77, 0
    s_mov_b32 s76, 0x8000
L_ldA_cnt:
    s_add_u32 s78, s76, 0
    buffer_load_dwordx4 v[16:19], v10, s[68:71], s78 offen sc1
    s_add_u32 s78, s76, 8192
    buffer_load_dwordx4 v[20:23], v10, s[68:71], s78 offen sc1
    s_add_u32 s78, s76, 16384
    buffer_load_dwordx4 v[24:27], v10, s[68:71], s78 offen sc1
    s_add_u32 s78, s76, 24576
    buffer_load_dwordx4 v[28:31], v10, s[68:71], s78 offen sc1
    s_add_u32 s77, s77, 1
    s_waitcnt vmcnt(0)
    v_cmp_ne_u64 vcc, s[46:47], v[18:19]
    v_cmp_ne_u64 s[12:13], s[46:47], v[22:23]
    s_nop 0
    s_or_b64 vcc, vcc, s[12:13]
    v_cmp_ne_u64 s[12:13], s[46:47], v[26:27]
    s_nop 0
    s_or_b64 vcc, vcc, s[12:13]
    v_cmp_ne_u64 s[12:13], s[46:47], v[30:31]
    s_nop 0
    s_or_b64 vcc, vcc, s[12:13]
    s_cmp_ge_u32 s77, 1048576
    s_cbranch_scc1 L_ldA_noepoch
    s_cmp_eq_u64 vcc, 0
    s_cbranch_scc0 L_ldA_cnt
    v_mov_b32 v10, 0
    s_mov_b64 exec, 1
    v_mov_b32 v12, s46
    v_mov_b32 v13, s47
    buffer_store_dwordx2 v[12:13], v10, s[68:71], 0 offen sc1
    s_waitcnt vmcnt(0)
L_ldA_noepoch:
    s_endpgm
L_ldB_tail:
    s_waitcnt vmcnt(8)
    s_waitcnt lgkmcnt(0)
    s_add_u32 s46, s46, 1
    s_addc_u32 s47, s47, 0
    s_barrier
    s_add_u32 s78, s11, s82
    s_add_u32 m0, s12, 0x10000
    s_add_u32 s79, s78, 0x0
    buffer_load_dwordx4 v2, s[48:51], s79 offen lds
    s_add_u32 m0, s12, 0x10400
    s_add_u32 s79, s78, 0x10000
    buffer_load_dwordx4 v2, s[48:51], s79 offen lds
    s_add_u32 m0, s12, 0x10800
    s_add_u32 s79, s78, 0x400
    buffer_load_dwordx4 v2, s[48:51], s79 offen lds
    s_add_u32 m0, s12, 0x10c00
    s_add_u32 s79, s78, 0x10400
    buffer_load_dwordx4 v2, s[48:51], s79 offen lds
    s_add_u32 s78, s13, s82
    s_add_u32 m0, s12, 0x14000
    s_add_u32 s79, s78, 0x0
    buffer_load_dwordx4 v3, s[52:55], s79 offen lds
    s_add_u32 m0, s12, 0x14400
    s_add_u32 s79, s78, 0x2000
    buffer_load_dwordx4 v4, s[52:55], s79 offen lds
    s_add_u32 m0, s12, 0x14800
    s_add_u32 s79, s78, 0x0
    buffer_load_dwordx4 v5, s[56:59], s79 offen lds
    s_add_u32 m0, s12, 0x14c00
    s_add_u32 s79, s78, 0x2000
    buffer_load_dwordx4 v6, s[56:59], s79 offen lds
    s_waitcnt vmcnt(8)
    s_barrier
    s_add_u32 s78, s11, s83
    s_add_u32 m0, s12, 0x18000
    s_add_u32 s79, s78, 0x0
    buffer_load_dwordx4 v2, s[48:51], s79 offen lds
    s_add_u32 m0, s12, 0x18400
    s_add_u32 s79, s78, 0x10000
    buffer_load_dwordx4 v2, s[48:51], s79 offen lds
    s_add_u32 m0, s12, 0x18800
    s_add_u32 s79, s78, 0x400
    buffer_load_dwordx4 v2, s[48:51], s79 offen lds
    s_add_u32 m0, s12, 0x18c00
    s_add_u32 s79, s78, 0x10400
    buffer_load_dwordx4 v2, s[48:51], s79 offen lds
    s_add_u32 s78, s13, s83
    s_add_u32 m0, s12, 0x1c000
    s_add_u32 s79, s78, 0x0
    buffer_load_dwordx4 v3, s[52:55], s79 offen lds
    s_add_u32 m0, s12, 0x1c400
    s_add_u32 s79, s78, 0x2000
    buffer_load_dwordx4 v4, s[52:55], s79 offen lds
    s_add_u32 m0, s12, 0x1c800
    s_add_u32 s79, s78, 0x0
    buffer_load_dwordx4 v5, s[56:59], s79 offen lds
    s_add_u32 m0, s12, 0x1cc00
    s_add_u32 s79, s78, 0x2000
    buffer_load_dwordx4 v6, s[56:59], s79 offen lds
    s_waitcnt vmcnt(8)
    s_barrier
    s_add_u32 s78, s11, s84
    s_add_u32 m0, s12, 0x0
    s_add_u32 s79, s78, 0x0
    buffer_load_dwordx4 v2, s[48:51], s79 offen lds
    s_add_u32 m0, s12, 0x400
    s_add_u32 s79, s78, 0x10000
    buffer_load_dwordx4 v2, s[48:51], s79 offen lds
    s_add_u32 m0, s12, 0x800
    s_add_u32 s79, s78, 0x400
    buffer_load_dwordx4 v2, s[48:51], s79 offen lds
    s_add_u32 m0, s12, 0xc00
    s_add_u32 s79, s78, 0x10400
    buffer_load_dwordx4 v2, s[48:51], s79 offen lds
    s_add_u32 s78, s13, s84
    s_add_u32 m0, s12, 0x4000
    s_add_u32 s79, s78, 0x0
    buffer_load_dwordx4 v3, s[52:55], s79 offen lds
    s_add_u32 m0, s12, 0x4400
    s_add_u32 s79, s78, 0x2000
    buffer_load_dwordx4 v4, s[52:55], s79 offen lds
    s_add_u32 m0, s12, 0x4800
    s_add_u32 s79, s78, 0x0
    buffer_load_dwordx4 v5, s[56:59], s79 offen lds
    s_add_u32 m0, s12, 0x4c00
    s_add_u32 s79, s78, 0x2000
    buffer_load_dwordx4 v6, s[56:59], s79 offen lds
    s_add_u32 s78, s11, s85
    s_add_u32 m0, s12, 0x8000
    s_add_u32 s79, s78, 0x0
    buffer_load_dwordx4 v2, s[48:51], s79 offen lds
    s_add_u32 m0, s12, 0x8400
    s_add_u32 s79, s78, 0x10000
    buffer_load_dwordx4 v2, s[48:51], s79 offen lds
    s_add_u32 m0, s12, 0x8800
    s_add_u32 s79, s78, 0x400
    buffer_load_dwordx4 v2, s[48:51], s79 offen lds
    s_add_u32 m0, s12, 0x8c00
    s_add_u32 s79, s78, 0x10400
    buffer_load_dwordx4 v2, s[48:51], s79 offen lds
    s_add_u32 s78, s13, s85
    s_add_u32 m0, s12, 0xc000
    s_add_u32 s79, s78, 0x0
    buffer_load_dwordx4 v3, s[52:55], s79 offen lds
    s_add_u32 m0, s12, 0xc400
    s_add_u32 s79, s78, 0x2000
    buffer_load_dwordx4 v4, s[52:55], s79 offen lds
    s_add_u32 m0, s12, 0xc800
    s_add_u32 s79, s78, 0x0
    buffer_load_dwordx4 v5, s[56:59], s79 offen lds
    s_add_u32 m0, s12, 0xcc00
    s_add_u32 s79, s78, 0x2000
    buffer_load_dwordx4 v6, s[56:59], s79 offen lds
    v_lshlrev_b32 v21, 7, v0
    s_mov_b32 s96, s40
    s_mov_b32 s97, s41
    s_mov_b32 s98, 0x800000
    s_mov_b32 s99, 0x00020000
    s_cmp_lg_u32 s10, 0
    s_cbranch_scc1 L_pf1_3_2
    s_mov_b32 s77, 0
    s_and_b32 s76, s77, 1
    s_lshl_b32 s76, s76, 13
    s_lshl_b32 s78, s5, 14
    s_add_u32 s76, s76, s78
    s_cmp_ge_u32 s77, 2
    s_cbranch_scc1 L_pf1_3_2_im
    buffer_load_dword v20, v21, s[60:63], s76 offen
    s_branch L_pf1_3_2_j
L_pf1_3_2_im:
    buffer_load_dword v20, v21, s[64:67], s76 offen
L_pf1_3_2_j:
L_pf1_3_2:
    s_cmp_lg_u32 s10, 1
    s_cbranch_scc1 L_pf1_3_3
    s_mov_b32 s77, 1
    s_and_b32 s76, s77, 1
    s_lshl_b32 s76, s76, 13
    s_lshl_b32 s78, s5, 14
    s_add_u32 s76, s76, s78
    s_cmp_ge_u32 s77, 2
    s_cbranch_scc1 L_pf1_3_3_im
    buffer_load_dword v20, v21, s[60:63], s76 offen
    s_branch L_pf1_3_3_j
L_pf1_3_3_im:
    buffer_load_dword v20, v21, s[64:67], s76 offen
L_pf1_3_3_j:
L_pf1_3_3:
    s_cmp_lg_u32 s10, 0
    s_cbranch_scc1 L_wx7_0
    s_waitcnt vmcnt(17)
    s_branch L_wx7_done
L_wx7_0:
    s_cmp_lg_u32 s10, 1
    s_cbranch_scc1 L_wx7_1
    s_waitcnt vmcnt(17)
    s_branch L_wx7_done
L_wx7_1:
    s_cmp_lg_u32 s10, 2
    s_cbranch_scc1 L_wx7_2
    s_waitcnt vmcnt(16)
    s_branch L_wx7_done
L_wx7_2:
    s_waitcnt vmcnt(16)
L_wx7_done:
    s_barrier
    s_add_u32 s78, s11, s86
    s_add_u32 m0, s12, 0x10000
    s_add_u32 s79, s78, 0x0
    buffer_load_dwordx4 v2, s[48:51], s79 offen lds
    s_add_u32 m0, s12, 0x10400
    s_add_u32 s79, s78, 0x10000
    buffer_load_dwordx4 v2, s[48:51], s79 offen lds
    s_add_u32 m0, s12, 0x10800
    s_add_u32 s79, s78, 0x400
    buffer_load_dwordx4 v2, s[48:51], s79 offen lds
    s_add_u32 m0, s12, 0x10c00
    s_add_u32 s79, s78, 0x10400
    buffer_load_dwordx4 v2, s[48:51], s79 offen lds
    s_add_u32 s78, s13, s86
    s_add_u32 m0, s12, 0x14000
    s_add_u32 s79, s78, 0x0
    buffer_load_dwordx4 v3, s[52:55], s79 offen lds
    s_add_u32 m0, s12, 0x14400
    s_add_u32 s79, s78, 0x2000
    buffer_load_dwordx4 v4, s[52:55], s79 offen lds
    s_add_u32 m0, s12, 0x14800
    s_add_u32 s79, s78, 0x0
    buffer_load_dwordx4 v5, s[56:59], s79 offen lds
    s_add_u32 m0, s12, 0x14c00
    s_add_u32 s79, s78, 0x2000
    buffer_load_dwordx4 v6, s[56:59], s79 offen lds
    s_cmp_lg_u32 s10, 2
    s_cbranch_scc1 L_pf1_4_1
    s_mov_b32 s77, 2
    s_and_b32 s76, s77, 1
    s_lshl_b32 s76, s76, 13
    s_lshl_b32 s78, s5, 14
    s_add_u32 s76, s76, s78
    s_cmp_ge_u32 s77, 2
    s_cbranch_scc1 L_pf1_4_1_im
    buffer_load_dword v20, v21, s[60:63], s76 offen
    s_branch L_pf1_4_1_j
L_pf1_4_1_im:
    buffer_load_dword v20, v21, s[64:67], s76 offen
L_pf1_4_1_j:
L_pf1_4_1:
    s_cmp_lg_u32 s10, 3
    s_cbranch_scc1 L_pf1_4_2
    s_mov_b32 s77, 3
    s_and_b32 s76, s77, 1
    s_lshl_b32 s76, s76, 13
    s_lshl_b32 s78, s5, 14
    s_add_u32 s76, s76, s78
    s_cmp_ge_u32 s77, 2
    s_cbranch_scc1 L_pf1_4_2_im
    buffer_load_dword v20, v21, s[60:63], s76 offen
    s_branch L_pf1_4_2_j
L_pf1_4_2_im:
    buffer_load_dword v20, v21, s[64:67], s76 offen
L_pf1_4_2_j:
L_pf1_4_2:
    s_waitcnt vmcnt(17)
    s_barrier
    s_add_u32 s78, s11, s87
    s_add_u32 m0, s12, 0x18000
    s_add_u32 s79, s78, 0x0
    buffer_load_dwordx4 v2, s[48:51], s79 offen lds
    s_add_u32 m0, s12, 0x18400
    s_add_u32 s79, s78, 0x10000
    buffer_load_dwordx4 v2, s[48:51], s79 offen lds
    s_add_u32 m0, s12, 0x18800
    s_add_u32 s79, s78, 0x400
    buffer_load_dwordx4 v2, s[48:51], s79 offen lds
    s_add_u32 m0, s12, 0x18c00
    s_add_u32 s79, s78, 0x10400
    buffer_load_dwordx4 v2, s[48:51], s79 offen lds
    s_add_u32 s78, s13, s87
    s_add_u32 m0, s12, 0x1c000
    s_add_u32 s79, s78, 0x0
    buffer_load_dwordx4 v3, s[52:55], s79 offen lds
    s_add_u32 m0, s12, 0x1c400
    s_add_u32 s79, s78, 0x2000
    buffer_load_dwordx4 v4, s[52:55], s79 offen lds
    s_add_u32 m0, s12, 0x1c800
    s_add_u32 s79, s78, 0x0
    buffer_load_dwordx4 v5, s[56:59], s79 offen lds
    s_add_u32 m0, s12, 0x1cc00
    s_add_u32 s79, s78, 0x2000
    buffer_load_dwordx4 v6, s[56:59], s79 offen lds
    s_waitcnt vmcnt(17)
    s_barrier
    s_cmp_lg_u32 s10, 0
    s_cbranch_scc1 L_wx8_0
    s_waitcnt vmcnt(8)
    s_branch L_wx8_done
L_wx8_0:
    s_cmp_lg_u32 s10, 1
    s_cbranch_scc1 L_wx8_1
    s_waitcnt vmcnt(8)
    s_branch L_wx8_done
L_wx8_1:
    s_cmp_lg_u32 s10, 2
    s_cbranch_scc1 L_wx8_2
    s_waitcnt vmcnt(9)
    s_branch L_wx8_done
L_wx8_2:
    s_waitcnt vmcnt(9)
L_wx8_done:
    s_barrier
    s_add_u32 s77, s10, 0
    s_lshl_b32 s76, s6, 5
    s_lshl_b32 s78, s7, 2
    s_add_u32 s76, s76, s78
    s_add_u32 s76, s76, s77
    s_lshl_b32 s76, s76, 13
    s_add_u32 s76, s76, 0x400000
    buffer_load_dword v20, v21, s[68:71], s76 offen
    s_cmp_lg_u32 s10, 0
    s_cbranch_scc1 L_pf1_7_1
    s_lshl_b32 s76, s6, 8
    s_add_u32 s76, s76, 0x2000
    buffer_load_dword v20, v21, s[68:71], s76 offen
L_pf1_7_1:
    s_cmp_lg_u32 s10, 0
    s_cbranch_scc1 L_wx9_0
    s_waitcnt vmcnt(2)
    s_branch L_wx9_done
L_wx9_0:
    s_cmp_lg_u32 s10, 1
    s_cbranch_scc1 L_wx9_1
    s_waitcnt vmcnt(1)
    s_branch L_wx9_done
L_wx9_1:
    s_cmp_lg_u32 s10, 2
    s_cbranch_scc1 L_wx9_2
    s_waitcnt vmcnt(1)
    s_branch L_wx9_done
L_wx9_2:
    s_waitcnt vmcnt(1)
L_wx9_done:
    s_barrier
    s_barrier
    s_barrier
    s_add_u32 s76, s10, 0
    s_lshl_b32 s76, s76, 4
    v_xor_b32 v15, s76, v14
    s_add_u32 m0, s15, 0x0
    s_add_u32 s79, s14, 0x0
    buffer_load_dwordx4 v15, s[60:63], s79 offen lds
    s_add_u32 m0, s15, 0x400
    s_add_u32 s79, s14, 0x0
    buffer_load_dwordx4 v15, s[64:67], s79 offen lds
    s_add_u32 m0, s15, 0x800
    s_add_u32 s79, s14, 0x400
    buffer_load_dwordx4 v15, s[60:63], s79 offen lds
    s_add_u32 m0, s15, 0xc00
    s_add_u32 s79, s14, 0x400
    buffer_load_dwordx4 v15, s[64:67], s79 offen lds
    s_add_u32 m0, s15, 0x1000
    s_add_u32 s79, s14, 0x800
    buffer_load_dwordx4 v15, s[60:63], s79 offen lds
    s_add_u32 m0, s15, 0x1400
    s_add_u32 s79, s14, 0x800
    buffer_load_dwordx4 v15, s[64:67], s79 offen lds
    s_add_u32 m0, s15, 0x1800
    s_add_u32 s79, s14, 0xc00
    buffer_load_dwordx4 v15, s[60:63], s79 offen lds
    s_add_u32 m0, s15, 0x1c00
    s_add_u32 s79, s14, 0xc00
    buffer_load_dwordx4 v15, s[64:67], s79 offen lds
    s_add_u32 s76, s10, 4
    s_lshl_b32 s76, s76, 4
    v_xor_b32 v15, s76, v14
    s_add_u32 m0, s15, 0x8000
    s_add_u32 s79, s14, 0x4000
    buffer_load_dwordx4 v15, s[60:63], s79 offen lds
    s_add_u32 m0, s15, 0x8400
    s_add_u32 s79, s14, 0x4000
    buffer_load_dwordx4 v15, s[64:67], s79 offen lds
    s_add_u32 m0, s15, 0x8800
    s_add_u32 s79, s14, 0x4400
    buffer_load_dwordx4 v15, s[60:63], s79 offen lds
    s_add_u32 m0, s15, 0x8c00
    s_add_u32 s79, s14, 0x4400
    buffer_load_dwordx4 v15, s[64:67], s79 offen lds
    s_add_u32 m0, s15, 0x9000
    s_add_u32 s79, s14, 0x4800
    buffer_load_dwordx4 v15, s[60:63], s79 offen lds
    s_add_u32 m0, s15, 0x9400
    s_add_u32 s79, s14, 0x4800
    buffer_load_dwordx4 v15, s[64:67], s79 offen lds
    s_add_u32 m0, s15, 0x9800
    s_add_u32 s79, s14, 0x4c00
    buffer_load_dwordx4 v15, s[60:63], s79 offen lds
    s_add_u32 m0, s15, 0x9c00
    s_add_u32 s79, s14, 0x4c00
    buffer_load_dwordx4 v15, s[64:67], s79 offen lds
    s_add_u32 s76, s10, 8
    s_lshl_b32 s76, s76, 4
    v_xor_b32 v15, s76, v14
    s_add_u32 m0, s15, 0x10000
    s_add_u32 s79, s14, 0x8000
    buffer_load_dwordx4 v15, s[60:63], s79 offen lds
    s_add_u32 m0, s15, 0x10400
    s_add_u32 s79, s14, 0x8000
    buffer_load_dwordx4 v15, s[64:67], s79 offen lds
    s_add_u32 m0, s15, 0x10800
    s_add_u32 s79, s14, 0x8400
    buffer_load_dwordx4 v15, s[60:63], s79 offen lds
    s_add_u32 m0, s15, 0x10c00
    s_add_u32 s79, s14, 0x8400
    buffer_load_dwordx4 v15, s[64:67], s79 offen lds
    s_add_u32 m0, s15, 0x11000
    s_add_u32 s79, s14, 0x8800
    buffer_load_dwordx4 v15, s[60:63], s79 offen lds
    s_add_u32 m0, s15, 0x11400
    s_add_u32 s79, s14, 0x8800
    buffer_load_dwordx4 v15, s[64:67], s79 offen lds
    s_add_u32 m0, s15, 0x11800
    s_add_u32 s79, s14, 0x8c00
    buffer_load_dwordx4 v15, s[60:63], s79 offen lds
    s_add_u32 m0, s15, 0x11c00
    s_add_u32 s79, s14, 0x8c00
    buffer_load_dwordx4 v15, s[64:67], s79 offen lds
    s_add_u32 s76, s10, 12
    s_lshl_b32 s76, s76, 4
    v_xor_b32 v15, s76, v14
    s_add_u32 m0, s15, 0x18000
    s_add_u32 s79, s14, 0xc000
    buffer_load_dwordx4 v15, s[60:63], s79 offen lds
    s_add_u32 m0, s15, 0x18400
    s_add_u32 s79, s14, 0xc000
    buffer_load_dwordx4 v15, s[64:67], s79 offen lds
    s_add_u32 m0, s15, 0x18800
    s_add_u32 s79, s14, 0xc400
    buffer_load_dwordx4 v15, s[60:63], s79 offen lds
    s_add_u32 m0, s15, 0x18c00
    s_add_u32 s79, s14, 0xc400
    buffer_load_dwordx4 v15, s[64:67], s79 offen lds
    s_add_u32 m0, s15, 0x19000
    s_add_u32 s79, s14, 0xc800
    buffer_load_dwordx4 v15, s[60:63], s79 offen lds
    s_add_u32 m0, s15, 0x19400
    s_add_u32 s79, s14, 0xc800
    buffer_load_dwordx4 v15, s[64:67], s79 offen lds
    s_add_u32 m0, s15, 0x19800
    s_add_u32 s79, s14, 0xcc00
    buffer_load_dwordx4 v15, s[60:63], s79 offen lds
    s_add_u32 m0, s15, 0x19c00
    s_add_u32 s79, s14, 0xcc00
    buffer_load_dwordx4 v15, s[64:67], s79 offen lds
    s_waitcnt vmcnt(0)
    s_barrier
    s_cmp_lg_u32 s10, 0
    s_cbranch_scc1 L_ldB_nopoll
    v_and_b32 v10, 31, v0
    v_lshlrev_b32 v10, 3, v10
    s_lshl_b32 s76, s6, 8
    s_add_u32 s76, s76, 0x2000
    s_mov_b32 s77, 0
L_ldB_poll:
    buffer_load_dwordx2 v[12:13], v10, s[68:71], s76 offen sc1
    s_add_u32 s77, s77, 1
    s_waitcnt vmcnt(0)
    v_cmp_ne_u64 vcc, s[46:47], v[12:13]
    s_cmp_ge_u32 s77, 1048576
    s_cbranch_scc1 L_ldB_nopoll
    s_cmp_eq_u64 vcc, 0
    s_cbranch_scc0 L_ldB_poll
L_ldB_nopoll:
    s_barrier
    s_or_b32 s76, s2, s10
    s_cmp_lg_u32 s76, 0
    s_cbranch_scc1 L_ldB_noepoch
    v_lshlrev_b32 v10, 7, v0
    s_mov_b32 s77, 0
    s_mov_b32 s76, 0x8000
L_ldB_cnt:
    s_add_u32 s78, s76, 0
    buffer_load_dwordx4 v[16:19], v10, s[68:71], s78 offen sc1
    s_add_u32 s78, s76, 8192
    buffer_load_dwordx4 v[20:23], v10, s[68:71], s78 offen sc1
    s_add_u32 s78, s76, 16384
    buffer_load_dwordx4 v[24:27], v10, s[68:71], s78 offen sc1
    s_add_u32 s78, s76, 24576
    buffer_load_dwordx4 v[28:31], v10, s[68:71], s78 offen sc1
    s_add_u32 s77, s77, 1
    s_waitcnt vmcnt(0)
    v_cmp_ne_u64 vcc, s[46:47], v[18:19]
    v_cmp_ne_u64 s[12:13], s[46:47], v[22:23]
    s_nop 0
    s_or_b64 vcc, vcc, s[12:13]
    v_cmp_ne_u64 s[12:13], s[46:47], v[26:27]
    s_nop 0
    s_or_b64 vcc, vcc, s[12:13]
    v_cmp_ne_u64 s[12:13], s[46:47], v[30:31]
    s_nop 0
    s_or_b64 vcc, vcc, s[12:13]
    s_cmp_ge_u32 s77, 1048576
    s_cbranch_scc1 L_ldB_noepoch
    s_cmp_eq_u64 vcc, 0
    s_cbranch_scc0 L_ldB_cnt
    v_mov_b32 v10, 0
    s_mov_b64 exec, 1
    v_mov_b32 v12, s46
    v_mov_b32 v13, s47
    buffer_store_dwordx2 v[12:13], v10, s[68:71], 0 offen sc1
    s_waitcnt vmcnt(0)
L_ldB_noepoch:
    s_endpgm
L_computeA:
    s_setprio 1
    v_and_b32 v1, 15, v0
    v_lshrrev_b32 v2, 4, v0
    v_and_b32 v213, 7, v1
    v_xor_b32 v213, v213, v2
    v_lshlrev_b32 v213, 4, v213
    v_lshl_add_u32 v200, v1, 7, v213
    v_xor_b32 v201, 64, v200
    s_lshl_b32 s76, s10, 1
    v_lshrrev_b32 v212, 2, v1
    v_lshl_add_u32 v212, v2, 3, v212
    v_bfe_u32 v213, v1, 1, 1
    v_bfe_u32 v214, v1, 3, 1
    v_lshlrev_b32 v214, 1, v214
    v_xor_b32 v213, v213, v214
    v_and_b32 v214, 1, v2
    v_lshlrev_b32 v214, 2, v214
    v_xor_b32 v213, v213, v214
    v_xor_b32 v213, s76, v213
    v_lshlrev_b32 v213, 4, v213
    v_lshl_add_u32 v212, v212, 7, v213
    v_and_b32 v214, 1, v1
    v_lshl_add_u32 v202, v214, 3, v212
    v_lshlrev_b32 v212, 2, v2
    v_sub_u32 v212, v1, v212
    v_mov_b32 v213, 0x3f80
    v_mov_b32 v214, 0x3f800000
    v_cmp_eq_u32 vcc, 0, v212
    s_nop 1
    v_cndmask_b32 v206, 0, v213, vcc
    v_cmp_eq_u32 vcc, 1, v212
    s_nop 1
    v_cndmask_b32 v206, v206, v214, vcc
    v_cmp_eq_u32 vcc, 2, v212
    s_nop 1
    v_cndmask_b32 v207, 0, v213, vcc
    v_cmp_eq_u32 vcc, 3, v212
    s_nop 1
    v_cndmask_b32 v207, v207, v214, vcc
    v_mov_b32 v208, 0x3f803f80
    v_mov_b32 v209, 0x3f803f80
    v_mov_b32 v210, 0x3f803f80
    v_mov_b32 v211, 0x3f803f80
    s_mov_b32 s96, 0x3fb8aa3b
    s_mov_b32 s97, 0x3fb8aa3b
    s_mov_b32 s98, 0x358637bd
    s_mov_b32 s99, 0x358637bd
    s_waitcnt lgkmcnt(0)
    s_load_dwordx2 s[46:47], s[44:45], 0
    s_mov_b32 s68, s44
    s_mov_b32 s69, s45
    s_mov_b32 s70, 0x1000000
    s_mov_b32 s71, 0x00020000
    s_mov_b32 s72, s40
    s_mov_b32 s73, s41
    s_mov_b32 s74, 0x800000
    s_mov_b32 s75, 0x00020000
    s_waitcnt lgkmcnt(0)
    s_add_u32 s46, s46, 1
    s_addc_u32 s47, s47, 0
    s_lshl_b32 s76, s10, 12
    v_add_u32 v238, s76, v200
    v_add_u32 v239, s76, v201
    v_lshrrev_b32 v212, 2, v1
    v_lshl_add_u32 v212, v2, 3, v212
    v_bfe_u32 v213, v1, 1, 1
    v_bfe_u32 v214, v1, 3, 1
    v_lshlrev_b32 v214, 1, v214
    v_xor_b32 v213, v213, v214
    v_and_b32 v214, 1, v2
    v_lshlrev_b32 v214, 2, v214
    v_xor_b32 v213, v213, v214
    v_lshlrev_b32 v213, 4, v213
    v_lshl_add_u32 v212, v212, 7, v213
    v_and_b32 v214, 1, v1
    v_lshl_add_u32 v240, v214, 3, v212
    v_xor_b32 v241, 32, v240
    v_xor_b32 v242, 64, v240
    v_xor_b32 v243, 96, v240
    s_barrier
    v_add_u32 v203, 65536, v200
    v_add_u32 v204, 65536, v201
    v_add_u32 v205, 81920, v202
    ds_read_b64_tr_b16 v[136:137], v205 offset:0
    ds_read_b64_tr_b16 v[138:139], v205 offset:512
    ds_read_b64_tr_b16 v[140:141], v205 offset:8192
    ds_read_b64_tr_b16 v[142:143], v205 offset:8704
    ds_read_b128 v[72:75], v203 offset:0
    ds_read_b128 v[76:79], v203 offset:2048
    ds_read_b128 v[80:83], v203 offset:4096
    ds_read_b128 v[84:87], v203 offset:6144
    ds_read_b128 v[88:91], v203 offset:8192
    ds_read_b128 v[92:95], v203 offset:10240
    ds_read_b128 v[96:99], v203 offset:12288
    ds_read_b128 v[100:103], v203 offset:14336
    s_cmp_lg_u32 s10, 0
    s_cbranch_scc1 L_A_noxcc
    s_getreg_b32 s76, hwreg(HW_REG_XCC_ID)
    s_and_b32 s76, s76, 15
    v_mov_b32 v232, s76
    v_mov_b32 v233, 1
    v_mov_b32 v234, s46
    v_mov_b32 v235, s47
    v_mov_b32 v236, 0
    s_lshl_b32 s77, s8, 4
    s_add_u32 s77, s77, s6
    s_lshl_b32 s77, s77, 3
    s_add_u32 s77, s77, s7
    s_lshl_b32 s77, s77, 7
    s_add_u32 s77, s77, 0x8000
    s_mov_b64 exec, 1
    buffer_store_dwordx4 v[232:235], v236, s[68:71], s77 offen sc1
    s_mov_b64 exec, -1
L_A_noxcc:
    s_waitcnt lgkmcnt(0)
    v_mfma_f32_16x16x32_bf16 v[8:11], v[72:75], v[136:139], 0
    ds_read_b64_tr_b16 v[144:145], v205 offset:4096
    v_mfma_f32_16x16x32_bf16 v[40:43], v[72:75], v[140:143], 0
    ds_read_b64_tr_b16 v[146:147], v205 offset:4608
    v_mfma_f32_16x16x32_bf16 v[12:15], v[76:79], v[136:139], 0
    ds_read_b64_tr_b16 v[148:149], v205 offset:12288
    v_mfma_f32_16x16x32_bf16 v[44:47], v[76:79], v[140:143], 0
    ds_read_b64_tr_b16 v[150:151], v205 offset:12800
    v_mfma_f32_16x16x32_bf16 v[16:19], v[80:83], v[136:139], 0
    ds_read_b128 v[104:107], v204 offset:0
    v_mfma_f32_16x16x32_bf16 v[48:51], v[80:83], v[140:143], 0
    ds_read_b128 v[108:111], v204 offset:2048
    v_mfma_f32_16x16x32_bf16 v[20:23], v[84:87], v[136:139], 0
    ds_read_b128 v[112:115], v204 offset:4096
    v_mfma_f32_16x16x32_bf16 v[52:55], v[84:87], v[140:143], 0
    ds_read_b128 v[116:119], v204 offset:6144
    v_mfma_f32_16x16x32_bf16 v[24:27], v[88:91], v[136:139], 0
    ds_read_b128 v[120:123], v204 offset:8192
    v_mfma_f32_16x16x32_bf16 v[56:59], v[88:91], v[140:143], 0
    ds_read_b128 v[124:127], v204 offset:10240
    v_mfma_f32_16x16x32_bf16 v[28:31], v[92:95], v[136:139], 0
    ds_read_b128 v[128:131], v204 offset:12288
    v_mfma_f32_16x16x32_bf16 v[60:63], v[92:95], v[140:143], 0
    ds_read_b128 v[132:135], v204 offset:14336
    v_mfma_f32_16x16x32_bf16 v[32:35], v[96:99], v[136:139], 0
    v_mfma_f32_16x16x32_bf16 v[64:67], v[96:99], v[140:143], 0
    v_mfma_f32_16x16x32_bf16 v[36:39], v[100:103], v[136:139], 0
    v_mfma_f32_16x16x32_bf16 v[68:71], v[100:103], v[140:143], 0
    s_waitcnt lgkmcnt(0)
    s_barrier
    v_add_u32 v203, 98304, v200
    v_add_u32 v204, 98304, v201
    v_add_u32 v205, 114688, v202
    v_mfma_f32_16x16x32_bf16 v[8:11], v[104:107], v[144:147], v[8:11]
    ds_read_b64_tr_b16 v[136:137], v205 offset:0
    v_mfma_f32_16x16x32_bf16 v[40:43], v[104:107], v[148:151], v[40:43]
    ds_read_b64_tr_b16 v[138:139], v205 offset:512
    v_mfma_f32_16x16x32_bf16 v[12:15], v[108:111], v[144:147], v[12:15]
    ds_read_b64_tr_b16 v[140:141], v205 offset:8192
    v_mfma_f32_16x16x32_bf16 v[44:47], v[108:111], v[148:151], v[44:47]
    ds_read_b64_tr_b16 v[142:143], v205 offset:8704
    v_mfma_f32_16x16x32_bf16 v[16:19], v[112:115], v[144:147], v[16:19]
    ds_read_b128 v[72:75], v203 offset:0
    v_mfma_f32_16x16x32_bf16 v[48:51], v[112:115], v[148:151], v[48:51]
    ds_read_b128 v[76:79], v203 offset:2048
    v_mfma_f32_16x16x32_bf16 v[20:23], v[116:119], v[144:147], v[20:23]
    ds_read_b128 v[80:83], v203 offset:4096
    v_mfma_f32_16x16x32_bf16 v[52:55], v[116:119], v[148:151], v[52:55]
    ds_read_b128 v[84:87], v203 offset:6144
    v_mfma_f32_16x16x32_bf16 v[24:27], v[120:123], v[144:147], v[24:27]
    ds_read_b128 v[88:91], v203 offset:8192
    v_mfma_f32_16x16x32_bf16 v[56:59], v[120:123], v[148:151], v[56:59]
    ds_read_b128 v[92:95], v203 offset:10240
    v_mfma_f32_16x16x32_bf16 v[28:31], v[124:127], v[144:147], v[28:31]
    ds_read_b128 v[96:99], v203 offset:12288
    v_mfma_f32_16x16x32_bf16 v[60:63], v[124:127], v[148:151], v[60:63]
    ds_read_b128 v[100:103], v203 offset:14336
    v_mfma_f32_16x16x32_bf16 v[32:35], v[128:131], v[144:147], v[32:35]
    v_mfma_f32_16x16x32_bf16 v[64:67], v[128:131], v[148:151], v[64:67]
    v_mfma_f32_16x16x32_bf16 v[36:39], v[132:135], v[144:147], v[36:39]
    v_mfma_f32_16x16x32_bf16 v[68:71], v[132:135], v[148:151], v[68:71]
    s_waitcnt lgkmcnt(0)
    v_mfma_f32_16x16x32_bf16 v[8:11], v[72:75], v[136:139], v[8:11]
    ds_read_b64_tr_b16 v[144:145], v205 offset:4096
    v_mfma_f32_16x16x32_bf16 v[40:43], v[72:75], v[140:143], v[40:43]
    ds_read_b64_tr_b16 v[146:147], v205 offset:4608
    v_mfma_f32_16x16x32_bf16 v[12:15], v[76:79], v[136:139], v[12:15]
    ds_read_b64_tr_b16 v[148:149], v205 offset:12288
    v_mfma_f32_16x16x32_bf16 v[44:47], v[76:79], v[140:143], v[44:47]
    ds_read_b64_tr_b16 v[150:151], v205 offset:12800
    v_mfma_f32_16x16x32_bf16 v[16:19], v[80:83], v[136:139], v[16:19]
    ds_read_b128 v[104:107], v204 offset:0
    v_mfma_f32_16x16x32_bf16 v[48:51], v[80:83], v[140:143], v[48:51]
    ds_read_b128 v[108:111], v204 offset:2048
    v_mfma_f32_16x16x32_bf16 v[20:23], v[84:87], v[136:139], v[20:23]
    ds_read_b128 v[112:115], v204 offset:4096
    v_mfma_f32_16x16x32_bf16 v[52:55], v[84:87], v[140:143], v[52:55]
    ds_read_b128 v[116:119], v204 offset:6144
    v_mfma_f32_16x16x32_bf16 v[24:27], v[88:91], v[136:139], v[24:27]
    ds_read_b128 v[120:123], v204 offset:8192
    v_mfma_f32_16x16x32_bf16 v[56:59], v[88:91], v[140:143], v[56:59]
    ds_read_b128 v[124:127], v204 offset:10240
    v_mfma_f32_16x16x32_bf16 v[28:31], v[92:95], v[136:139], v[28:31]
    ds_read_b128 v[128:131], v204 offset:12288
    v_mfma_f32_16x16x32_bf16 v[60:63], v[92:95], v[140:143], v[60:63]
    ds_read_b128 v[132:135], v204 offset:14336
    v_mfma_f32_16x16x32_bf16 v[32:35], v[96:99], v[136:139], v[32:35]
    v_mfma_f32_16x16x32_bf16 v[64:67], v[96:99], v[140:143], v[64:67]
    v_mfma_f32_16x16x32_bf16 v[36:39], v[100:103], v[136:139], v[36:39]
    v_mfma_f32_16x16x32_bf16 v[68:71], v[100:103], v[140:143], v[68:71]
    s_waitcnt lgkmcnt(0)
    s_barrier
    v_add_u32 v203, 131072, v200
    v_add_u32 v204, 131072, v201
    v_add_u32 v205, 147456, v202
    v_mfma_f32_16x16x32_bf16 v[8:11], v[104:107], v[144:147], v[8:11]
    ds_read_b64_tr_b16 v[136:137], v205 offset:0
    v_mfma_f32_16x16x32_bf16 v[40:43], v[104:107], v[148:151], v[40:43]
    ds_read_b64_tr_b16 v[138:139], v205 offset:512
    v_mfma_f32_16x16x32_bf16 v[12:15], v[108:111], v[144:147], v[12:15]
    ds_read_b64_tr_b16 v[140:141], v205 offset:8192
    v_mfma_f32_16x16x32_bf16 v[44:47], v[108:111], v[148:151], v[44:47]
    ds_read_b64_tr_b16 v[142:143], v205 offset:8704
    v_mfma_f32_16x16x32_bf16 v[16:19], v[112:115], v[144:147], v[16:19]
    ds_read_b128 v[72:75], v203 offset:0
    v_mfma_f32_16x16x32_bf16 v[48:51], v[112:115], v[148:151], v[48:51]
    ds_read_b128 v[76:79], v203 offset:2048
    v_mfma_f32_16x16x32_bf16 v[20:23], v[116:119], v[144:147], v[20:23]
    ds_read_b128 v[80:83], v203 offset:4096
    v_mfma_f32_16x16x32_bf16 v[52:55], v[116:119], v[148:151], v[52:55]
    ds_read_b128 v[84:87], v203 offset:6144
    v_mfma_f32_16x16x32_bf16 v[24:27], v[120:123], v[144:147], v[24:27]
    ds_read_b128 v[88:91], v203 offset:8192
    v_mfma_f32_16x16x32_bf16 v[56:59], v[120:123], v[148:151], v[56:59]
    ds_read_b128 v[92:95], v203 offset:10240
    v_mfma_f32_16x16x32_bf16 v[28:31], v[124:127], v[144:147], v[28:31]
    ds_read_b128 v[96:99], v203 offset:12288
    v_mfma_f32_16x16x32_bf16 v[60:63], v[124:127], v[148:151], v[60:63]
    ds_read_b128 v[100:103], v203 offset:14336
    v_mfma_f32_16x16x32_bf16 v[32:35], v[128:131], v[144:147], v[32:35]
    v_mfma_f32_16x16x32_bf16 v[64:67], v[128:131], v[148:151], v[64:67]
    v_mfma_f32_16x16x32_bf16 v[36:39], v[132:135], v[144:147], v[36:39]
    v_mfma_f32_16x16x32_bf16 v[68:71], v[132:135], v[148:151], v[68:71]
    s_waitcnt lgkmcnt(0)
    v_mfma_f32_16x16x32_bf16 v[8:11], v[72:75], v[136:139], v[8:11]
    ds_read_b64_tr_b16 v[144:145], v205 offset:4096
    v_mfma_f32_16x16x32_bf16 v[40:43], v[72:75], v[140:143], v[40:43]
    ds_read_b64_tr_b16 v[146:147], v205 offset:4608
    v_mfma_f32_16x16x32_bf16 v[12:15], v[76:79], v[136:139], v[12:15]
    ds_read_b64_tr_b16 v[148:149], v205 offset:12288
    v_mfma_f32_16x16x32_bf16 v[44:47], v[76:79], v[140:143], v[44:47]
    ds_read_b64_tr_b16 v[150:151], v205 offset:12800
    v_mfma_f32_16x16x32_bf16 v[16:19], v[80:83], v[136:139], v[16:19]
    ds_read_b128 v[104:107], v204 offset:0
    v_mfma_f32_16x16x32_bf16 v[48:51], v[80:83], v[140:143], v[48:51]
    ds_read_b128 v[108:111], v204 offset:2048
    v_mfma_f32_16x16x32_bf16 v[20:23], v[84:87], v[136:139], v[20:23]
    ds_read_b128 v[112:115], v204 offset:4096
    v_mfma_f32_16x16x32_bf16 v[52:55], v[84:87], v[140:143], v[52:55]
    ds_read_b128 v[116:119], v204 offset:6144
    v_mfma_f32_16x16x32_bf16 v[24:27], v[88:91], v[136:139], v[24:27]
    ds_read_b128 v[120:123], v204 offset:8192
    v_mfma_f32_16x16x32_bf16 v[56:59], v[88:91], v[140:143], v[56:59]
    ds_read_b128 v[124:127], v204 offset:10240
    v_mfma_f32_16x16x32_bf16 v[28:31], v[92:95], v[136:139], v[28:31]
    ds_read_b128 v[128:131], v204 offset:12288
    v_mfma_f32_16x16x32_bf16 v[60:63], v[92:95], v[140:143], v[60:63]
    ds_read_b128 v[132:135], v204 offset:14336
    v_mfma_f32_16x16x32_bf16 v[32:35], v[96:99], v[136:139], v[32:35]
    v_mfma_f32_16x16x32_bf16 v[64:67], v[96:99], v[140:143], v[64:67]
    v_mfma_f32_16x16x32_bf16 v[36:39], v[100:103], v[136:139], v[36:39]
    v_mfma_f32_16x16x32_bf16 v[68:71], v[100:103], v[140:143], v[68:71]
    s_waitcnt lgkmcnt(0)
    s_barrier
    v_add_u32 v203, 65536, v200
    v_add_u32 v204, 65536, v201
    v_add_u32 v205, 81920, v202
    v_mfma_f32_16x16x32_bf16 v[8:11], v[104:107], v[144:147], v[8:11]
    ds_read_b64_tr_b16 v[136:137], v205 offset:0
    v_mfma_f32_16x16x32_bf16 v[40:43], v[104:107], v[148:151], v[40:43]
    ds_read_b64_tr_b16 v[138:139], v205 offset:512
    v_mfma_f32_16x16x32_bf16 v[12:15], v[108:111], v[144:147], v[12:15]
    ds_read_b64_tr_b16 v[140:141], v205 offset:8192
    v_mfma_f32_16x16x32_bf16 v[44:47], v[108:111], v[148:151], v[44:47]
    ds_read_b64_tr_b16 v[142:143], v205 offset:8704
    v_mfma_f32_16x16x32_bf16 v[16:19], v[112:115], v[144:147], v[16:19]
    ds_read_b128 v[72:75], v203 offset:0
    v_mfma_f32_16x16x32_bf16 v[48:51], v[112:115], v[148:151], v[48:51]
    ds_read_b128 v[76:79], v203 offset:2048
    v_mfma_f32_16x16x32_bf16 v[20:23], v[116:119], v[144:147], v[20:23]
    ds_read_b128 v[80:83], v203 offset:4096
    v_mfma_f32_16x16x32_bf16 v[52:55], v[116:119], v[148:151], v[52:55]
    ds_read_b128 v[84:87], v203 offset:6144
    v_mfma_f32_16x16x32_bf16 v[24:27], v[120:123], v[144:147], v[24:27]
    ds_read_b128 v[88:91], v203 offset:8192
    v_mfma_f32_16x16x32_bf16 v[56:59], v[120:123], v[148:151], v[56:59]
    ds_read_b128 v[92:95], v203 offset:10240
    v_mfma_f32_16x16x32_bf16 v[28:31], v[124:127], v[144:147], v[28:31]
    ds_read_b128 v[96:99], v203 offset:12288
    v_mfma_f32_16x16x32_bf16 v[60:63], v[124:127], v[148:151], v[60:63]
    ds_read_b128 v[100:103], v203 offset:14336
    v_mfma_f32_16x16x32_bf16 v[32:35], v[128:131], v[144:147], v[32:35]
    v_mfma_f32_16x16x32_bf16 v[64:67], v[128:131], v[148:151], v[64:67]
    v_mfma_f32_16x16x32_bf16 v[36:39], v[132:135], v[144:147], v[36:39]
    v_mfma_f32_16x16x32_bf16 v[68:71], v[132:135], v[148:151], v[68:71]
    s_waitcnt lgkmcnt(0)
    v_mfma_f32_16x16x32_bf16 v[8:11], v[72:75], v[136:139], v[8:11]
    ds_read_b64_tr_b16 v[144:145], v205 offset:4096
    v_mfma_f32_16x16x32_bf16 v[40:43], v[72:75], v[140:143], v[40:43]
    ds_read_b64_tr_b16 v[146:147], v205 offset:4608
    v_mfma_f32_16x16x32_bf16 v[12:15], v[76:79], v[136:139], v[12:15]
    ds_read_b64_tr_b16 v[148:149], v205 offset:12288
    v_mfma_f32_16x16x32_bf16 v[44:47], v[76:79], v[140:143], v[44:47]
    ds_read_b64_tr_b16 v[150:151], v205 offset:12800
    v_mfma_f32_16x16x32_bf16 v[16:19], v[80:83], v[136:139], v[16:19]
    ds_read_b128 v[104:107], v204 offset:0
    v_mfma_f32_16x16x32_bf16 v[48:51], v[80:83], v[140:143], v[48:51]
    ds_read_b128 v[108:111], v204 offset:2048
    v_mfma_f32_16x16x32_bf16 v[20:23], v[84:87], v[136:139], v[20:23]
    ds_read_b128 v[112:115], v204 offset:4096
    v_mfma_f32_16x16x32_bf16 v[52:55], v[84:87], v[140:143], v[52:55]
    ds_read_b128 v[116:119], v204 offset:6144
    v_mfma_f32_16x16x32_bf16 v[24:27], v[88:91], v[136:139], v[24:27]
    ds_read_b128 v[120:123], v204 offset:8192
    v_mfma_f32_16x16x32_bf16 v[56:59], v[88:91], v[140:143], v[56:59]
    ds_read_b128 v[124:127], v204 offset:10240
    v_mfma_f32_16x16x32_bf16 v[28:31], v[92:95], v[136:139], v[28:31]
    ds_read_b128 v[128:131], v204 offset:12288
    v_mfma_f32_16x16x32_bf16 v[60:63], v[92:95], v[140:143], v[60:63]
    ds_read_b128 v[132:135], v204 offset:14336
    v_mfma_f32_16x16x32_bf16 v[32:35], v[96:99], v[136:139], v[32:35]
    v_mfma_f32_16x16x32_bf16 v[64:67], v[96:99], v[140:143], v[64:67]
    v_mfma_f32_16x16x32_bf16 v[36:39], v[100:103], v[136:139], v[36:39]
    v_mfma_f32_16x16x32_bf16 v[68:71], v[100:103], v[140:143], v[68:71]
    s_waitcnt lgkmcnt(0)
    s_barrier
    v_add_u32 v203, 0, v200
    v_add_u32 v204, 0, v201
    v_add_u32 v205, 98304, v202
    v_mfma_f32_16x16x32_bf16 v[8:11], v[104:107], v[144:147], v[8:11]
    ds_read_b64_tr_b16 v[136:137], v205 offset:0
    v_mfma_f32_16x16x32_bf16 v[40:43], v[104:107], v[148:151], v[40:43]
    ds_read_b64_tr_b16 v[138:139], v205 offset:512
    v_mfma_f32_16x16x32_bf16 v[12:15], v[108:111], v[144:147], v[12:15]
    ds_read_b64_tr_b16 v[140:141], v205 offset:8192
    v_mfma_f32_16x16x32_bf16 v[44:47], v[108:111], v[148:151], v[44:47]
    ds_read_b64_tr_b16 v[142:143], v205 offset:8704
    v_mfma_f32_16x16x32_bf16 v[16:19], v[112:115], v[144:147], v[16:19]
    ds_read_b128 v[72:75], v203 offset:0
    v_mfma_f32_16x16x32_bf16 v[48:51], v[112:115], v[148:151], v[48:51]
    ds_read_b128 v[76:79], v203 offset:2048
    v_mfma_f32_16x16x32_bf16 v[20:23], v[116:119], v[144:147], v[20:23]
    ds_read_b128 v[80:83], v203 offset:4096
    v_mfma_f32_16x16x32_bf16 v[52:55], v[116:119], v[148:151], v[52:55]
    ds_read_b128 v[84:87], v203 offset:6144
    v_mfma_f32_16x16x32_bf16 v[24:27], v[120:123], v[144:147], v[24:27]
    ds_read_b128 v[88:91], v203 offset:8192
    v_mfma_f32_16x16x32_bf16 v[56:59], v[120:123], v[148:151], v[56:59]
    ds_read_b128 v[92:95], v203 offset:10240
    v_mfma_f32_16x16x32_bf16 v[28:31], v[124:127], v[144:147], v[28:31]
    ds_read_b128 v[96:99], v203 offset:12288
    v_mfma_f32_16x16x32_bf16 v[60:63], v[124:127], v[148:151], v[60:63]
    ds_read_b128 v[100:103], v203 offset:14336
    v_mfma_f32_16x16x32_bf16 v[32:35], v[128:131], v[144:147], v[32:35]
    v_mfma_f32_16x16x32_bf16 v[64:67], v[128:131], v[148:151], v[64:67]
    v_mfma_f32_16x16x32_bf16 v[36:39], v[132:135], v[144:147], v[36:39]
    v_mfma_f32_16x16x32_bf16 v[68:71], v[132:135], v[148:151], v[68:71]
    s_waitcnt lgkmcnt(0)
    v_mfma_f32_16x16x32_bf16 v[8:11], v[72:75], v[136:139], v[8:11]
    ds_read_b64_tr_b16 v[144:145], v205 offset:4096
    v_mfma_f32_16x16x32_bf16 v[40:43], v[72:75], v[140:143], v[40:43]
    ds_read_b64_tr_b16 v[146:147], v205 offset:4608
    v_mfma_f32_16x16x32_bf16 v[12:15], v[76:79], v[136:139], v[12:15]
    ds_read_b64_tr_b16 v[148:149], v205 offset:12288
    v_mfma_f32_16x16x32_bf16 v[44:47], v[76:79], v[140:143], v[44:47]
    ds_read_b64_tr_b16 v[150:151], v205 offset:12800
    v_mfma_f32_16x16x32_bf16 v[16:19], v[80:83], v[136:139], v[16:19]
    ds_read_b128 v[104:107], v204 offset:0
    v_mfma_f32_16x16x32_bf16 v[48:51], v[80:83], v[140:143], v[48:51]
    ds_read_b128 v[108:111], v204 offset:2048
    v_mfma_f32_16x16x32_bf16 v[20:23], v[84:87], v[136:139], v[20:23]
    ds_read_b128 v[112:115], v204 offset:4096
    v_mfma_f32_16x16x32_bf16 v[52:55], v[84:87], v[140:143], v[52:55]
    ds_read_b128 v[116:119], v204 offset:6144
    v_mfma_f32_16x16x32_bf16 v[24:27], v[88:91], v[136:139], v[24:27]
    ds_read_b128 v[120:123], v204 offset:8192
    v_mfma_f32_16x16x32_bf16 v[56:59], v[88:91], v[140:143], v[56:59]
    ds_read_b128 v[124:127], v204 offset:10240
    v_mfma_f32_16x16x32_bf16 v[28:31], v[92:95], v[136:139], v[28:31]
    ds_read_b128 v[128:131], v204 offset:12288
    v_mfma_f32_16x16x32_bf16 v[60:63], v[92:95], v[140:143], v[60:63]
    ds_read_b128 v[132:135], v204 offset:14336
    v_mfma_f32_16x16x32_bf16 v[32:35], v[96:99], v[136:139], v[32:35]
    v_mfma_f32_16x16x32_bf16 v[64:67], v[96:99], v[140:143], v[64:67]
    v_mfma_f32_16x16x32_bf16 v[36:39], v[100:103], v[136:139], v[36:39]
    v_mfma_f32_16x16x32_bf16 v[68:71], v[100:103], v[140:143], v[68:71]
    s_waitcnt lgkmcnt(0)
    s_barrier
    v_add_u32 v203, 16384, v200
    v_add_u32 v204, 16384, v201
    v_add_u32 v205, 114688, v202
    v_mfma_f32_16x16x32_bf16 v[8:11], v[104:107], v[144:147], v[8:11]
    ds_read_b64_tr_b16 v[136:137], v205 offset:0
    v_mfma_f32_16x16x32_bf16 v[40:43], v[104:107], v[148:151], v[40:43]
    ds_read_b64_tr_b16 v[138:139], v205 offset:512
    v_mfma_f32_16x16x32_bf16 v[12:15], v[108:111], v[144:147], v[12:15]
    ds_read_b64_tr_b16 v[140:141], v205 offset:8192
    v_mfma_f32_16x16x32_bf16 v[44:47], v[108:111], v[148:151], v[44:47]
    ds_read_b64_tr_b16 v[142:143], v205 offset:8704
    v_mfma_f32_16x16x32_bf16 v[16:19], v[112:115], v[144:147], v[16:19]
    ds_read_b128 v[72:75], v203 offset:0
    v_mfma_f32_16x16x32_bf16 v[48:51], v[112:115], v[148:151], v[48:51]
    ds_read_b128 v[76:79], v203 offset:2048
    v_mfma_f32_16x16x32_bf16 v[20:23], v[116:119], v[144:147], v[20:23]
    ds_read_b128 v[80:83], v203 offset:4096
    v_mfma_f32_16x16x32_bf16 v[52:55], v[116:119], v[148:151], v[52:55]
    ds_read_b128 v[84:87], v203 offset:6144
    v_mfma_f32_16x16x32_bf16 v[24:27], v[120:123], v[144:147], v[24:27]
    ds_read_b128 v[88:91], v203 offset:8192
    v_mfma_f32_16x16x32_bf16 v[56:59], v[120:123], v[148:151], v[56:59]
    ds_read_b128 v[92:95], v203 offset:10240
    v_mfma_f32_16x16x32_bf16 v[28:31], v[124:127], v[144:147], v[28:31]
    ds_read_b128 v[96:99], v203 offset:12288
    v_mfma_f32_16x16x32_bf16 v[60:63], v[124:127], v[148:151], v[60:63]
    ds_read_b128 v[100:103], v203 offset:14336
    v_mfma_f32_16x16x32_bf16 v[32:35], v[128:131], v[144:147], v[32:35]
    v_mfma_f32_16x16x32_bf16 v[64:67], v[128:131], v[148:151], v[64:67]
    v_mfma_f32_16x16x32_bf16 v[36:39], v[132:135], v[144:147], v[36:39]
    v_mfma_f32_16x16x32_bf16 v[68:71], v[132:135], v[148:151], v[68:71]
    s_waitcnt lgkmcnt(0)
    v_mfma_f32_16x16x32_bf16 v[8:11], v[72:75], v[136:139], v[8:11]
    ds_read_b64_tr_b16 v[144:145], v205 offset:4096
    v_mfma_f32_16x16x32_bf16 v[40:43], v[72:75], v[140:143], v[40:43]
    ds_read_b64_tr_b16 v[146:147], v205 offset:4608
    v_mfma_f32_16x16x32_bf16 v[12:15], v[76:79], v[136:139], v[12:15]
    ds_read_b64_tr_b16 v[148:149], v205 offset:12288
    v_mfma_f32_16x16x32_bf16 v[44:47], v[76:79], v[140:143], v[44:47]
    ds_read_b64_tr_b16 v[150:151], v205 offset:12800
    v_mfma_f32_16x16x32_bf16 v[16:19], v[80:83], v[136:139], v[16:19]
    ds_read_b128 v[104:107], v204 offset:0
    v_mfma_f32_16x16x32_bf16 v[48:51], v[80:83], v[140:143], v[48:51]
    ds_read_b128 v[108:111], v204 offset:2048
    v_mfma_f32_16x16x32_bf16 v[20:23], v[84:87], v[136:139], v[20:23]
    ds_read_b128 v[112:115], v204 offset:4096
    v_mfma_f32_16x16x32_bf16 v[52:55], v[84:87], v[140:143], v[52:55]
    ds_read_b128 v[116:119], v204 offset:6144
    v_mfma_f32_16x16x32_bf16 v[24:27], v[88:91], v[136:139], v[24:27]
    ds_read_b128 v[120:123], v204 offset:8192
    v_mfma_f32_16x16x32_bf16 v[56:59], v[88:91], v[140:143], v[56:59]
    ds_read_b128 v[124:127], v204 offset:10240
    v_mfma_f32_16x16x32_bf16 v[28:31], v[92:95], v[136:139], v[28:31]
    ds_read_b128 v[128:131], v204 offset:12288
    v_mfma_f32_16x16x32_bf16 v[60:63], v[92:95], v[140:143], v[60:63]
    ds_read_b128 v[132:135], v204 offset:14336
    v_mfma_f32_16x16x32_bf16 v[32:35], v[96:99], v[136:139], v[32:35]
    v_mfma_f32_16x16x32_bf16 v[64:67], v[96:99], v[140:143], v[64:67]
    v_mfma_f32_16x16x32_bf16 v[36:39], v[100:103], v[136:139], v[36:39]
    v_mfma_f32_16x16x32_bf16 v[68:71], v[100:103], v[140:143], v[68:71]
    s_waitcnt lgkmcnt(0)
    s_barrier
    v_add_u32 v203, 32768, v200
    v_add_u32 v204, 32768, v201
    v_add_u32 v205, 131072, v202
    v_mfma_f32_16x16x32_bf16 v[8:11], v[104:107], v[144:147], v[8:11]
    ds_read_b64_tr_b16 v[136:137], v205 offset:0
    v_mfma_f32_16x16x32_bf16 v[40:43], v[104:107], v[148:151], v[40:43]
    ds_read_b64_tr_b16 v[138:139], v205 offset:512
    v_mfma_f32_16x16x32_bf16 v[12:15], v[108:111], v[144:147], v[12:15]
    ds_read_b64_tr_b16 v[140:141], v205 offset:8192
    v_mfma_f32_16x16x32_bf16 v[44:47], v[108:111], v[148:151], v[44:47]
    ds_read_b64_tr_b16 v[142:143], v205 offset:8704
    v_mfma_f32_16x16x32_bf16 v[16:19], v[112:115], v[144:147], v[16:19]
    ds_read_b128 v[72:75], v203 offset:0
    v_mfma_f32_16x16x32_bf16 v[48:51], v[112:115], v[148:151], v[48:51]
    ds_read_b128 v[76:79], v203 offset:2048
    v_mfma_f32_16x16x32_bf16 v[20:23], v[116:119], v[144:147], v[20:23]
    ds_read_b128 v[80:83], v203 offset:4096
    v_mfma_f32_16x16x32_bf16 v[52:55], v[116:119], v[148:151], v[52:55]
    ds_read_b128 v[84:87], v203 offset:6144
    v_mfma_f32_16x16x32_bf16 v[24:27], v[120:123], v[144:147], v[24:27]
    ds_read_b128 v[88:91], v203 offset:8192
    v_mfma_f32_16x16x32_bf16 v[56:59], v[120:123], v[148:151], v[56:59]
    ds_read_b128 v[92:95], v203 offset:10240
    v_mfma_f32_16x16x32_bf16 v[28:31], v[124:127], v[144:147], v[28:31]
    ds_read_b128 v[96:99], v203 offset:12288
    v_mfma_f32_16x16x32_bf16 v[60:63], v[124:127], v[148:151], v[60:63]
    ds_read_b128 v[100:103], v203 offset:14336
    v_mfma_f32_16x16x32_bf16 v[32:35], v[128:131], v[144:147], v[32:35]
    v_mfma_f32_16x16x32_bf16 v[64:67], v[128:131], v[148:151], v[64:67]
    v_mfma_f32_16x16x32_bf16 v[36:39], v[132:135], v[144:147], v[36:39]
    v_mfma_f32_16x16x32_bf16 v[68:71], v[132:135], v[148:151], v[68:71]
    s_waitcnt lgkmcnt(0)
    v_mfma_f32_16x16x32_bf16 v[8:11], v[72:75], v[136:139], v[8:11]
    ds_read_b64_tr_b16 v[144:145], v205 offset:4096
    v_mfma_f32_16x16x32_bf16 v[40:43], v[72:75], v[140:143], v[40:43]
    ds_read_b64_tr_b16 v[146:147], v205 offset:4608
    v_mfma_f32_16x16x32_bf16 v[12:15], v[76:79], v[136:139], v[12:15]
    ds_read_b64_tr_b16 v[148:149], v205 offset:12288
    v_mfma_f32_16x16x32_bf16 v[44:47], v[76:79], v[140:143], v[44:47]
    ds_read_b64_tr_b16 v[150:151], v205 offset:12800
    v_mfma_f32_16x16x32_bf16 v[16:19], v[80:83], v[136:139], v[16:19]
    ds_read_b128 v[104:107], v204 offset:0
    v_mfma_f32_16x16x32_bf16 v[48:51], v[80:83], v[140:143], v[48:51]
    ds_read_b128 v[108:111], v204 offset:2048
    v_mfma_f32_16x16x32_bf16 v[20:23], v[84:87], v[136:139], v[20:23]
    ds_read_b128 v[112:115], v204 offset:4096
    v_mfma_f32_16x16x32_bf16 v[52:55], v[84:87], v[140:143], v[52:55]
    ds_read_b128 v[116:119], v204 offset:6144
    v_mfma_f32_16x16x32_bf16 v[24:27], v[88:91], v[136:139], v[24:27]
    ds_read_b128 v[120:123], v204 offset:8192
    v_mfma_f32_16x16x32_bf16 v[56:59], v[88:91], v[140:143], v[56:59]
    ds_read_b128 v[124:127], v204 offset:10240
    v_mfma_f32_16x16x32_bf16 v[28:31], v[92:95], v[136:139], v[28:31]
    ds_read_b128 v[128:131], v204 offset:12288
    v_mfma_f32_16x16x32_bf16 v[60:63], v[92:95], v[140:143], v[60:63]
    ds_read_b128 v[132:135], v204 offset:14336
    v_mfma_f32_16x16x32_bf16 v[32:35], v[96:99], v[136:139], v[32:35]
    v_mfma_f32_16x16x32_bf16 v[64:67], v[96:99], v[140:143], v[64:67]
    v_mfma_f32_16x16x32_bf16 v[36:39], v[100:103], v[136:139], v[36:39]
    v_mfma_f32_16x16x32_bf16 v[68:71], v[100:103], v[140:143], v[68:71]
    s_waitcnt lgkmcnt(0)
    s_barrier
    v_add_u32 v203, 49152, v200
    v_add_u32 v204, 49152, v201
    v_add_u32 v205, 147456, v202
    v_mfma_f32_16x16x32_bf16 v[8:11], v[104:107], v[144:147], v[8:11]
    ds_read_b64_tr_b16 v[136:137], v205 offset:0
    v_mfma_f32_16x16x32_bf16 v[40:43], v[104:107], v[148:151], v[40:43]
    ds_read_b64_tr_b16 v[138:139], v205 offset:512
    v_mfma_f32_16x16x32_bf16 v[12:15], v[108:111], v[144:147], v[12:15]
    ds_read_b64_tr_b16 v[140:141], v205 offset:8192
    v_mfma_f32_16x16x32_bf16 v[44:47], v[108:111], v[148:151], v[44:47]
    ds_read_b64_tr_b16 v[142:143], v205 offset:8704
    v_mfma_f32_16x16x32_bf16 v[16:19], v[112:115], v[144:147], v[16:19]
    ds_read_b128 v[72:75], v203 offset:0
    v_mfma_f32_16x16x32_bf16 v[48:51], v[112:115], v[148:151], v[48:51]
    ds_read_b128 v[76:79], v203 offset:2048
    v_mfma_f32_16x16x32_bf16 v[20:23], v[116:119], v[144:147], v[20:23]
    ds_read_b128 v[80:83], v203 offset:4096
    v_mfma_f32_16x16x32_bf16 v[52:55], v[116:119], v[148:151], v[52:55]
    ds_read_b128 v[84:87], v203 offset:6144
    v_mfma_f32_16x16x32_bf16 v[24:27], v[120:123], v[144:147], v[24:27]
    ds_read_b128 v[88:91], v203 offset:8192
    v_mfma_f32_16x16x32_bf16 v[56:59], v[120:123], v[148:151], v[56:59]
    ds_read_b128 v[92:95], v203 offset:10240
    v_mfma_f32_16x16x32_bf16 v[28:31], v[124:127], v[144:147], v[28:31]
    ds_read_b128 v[96:99], v203 offset:12288
    v_mfma_f32_16x16x32_bf16 v[60:63], v[124:127], v[148:151], v[60:63]
    ds_read_b128 v[100:103], v203 offset:14336
    v_mfma_f32_16x16x32_bf16 v[32:35], v[128:131], v[144:147], v[32:35]
    v_mfma_f32_16x16x32_bf16 v[64:67], v[128:131], v[148:151], v[64:67]
    v_mfma_f32_16x16x32_bf16 v[36:39], v[132:135], v[144:147], v[36:39]
    v_mfma_f32_16x16x32_bf16 v[68:71], v[132:135], v[148:151], v[68:71]
    s_waitcnt lgkmcnt(0)
    v_mfma_f32_16x16x32_bf16 v[8:11], v[72:75], v[136:139], v[8:11]
    ds_read_b64_tr_b16 v[144:145], v205 offset:4096
    v_mfma_f32_16x16x32_bf16 v[40:43], v[72:75], v[140:143], v[40:43]
    ds_read_b64_tr_b16 v[146:147], v205 offset:4608
    v_mfma_f32_16x16x32_bf16 v[12:15], v[76:79], v[136:139], v[12:15]
    ds_read_b64_tr_b16 v[148:149], v205 offset:12288
    v_mfma_f32_16x16x32_bf16 v[44:47], v[76:79], v[140:143], v[44:47]
    ds_read_b64_tr_b16 v[150:151], v205 offset:12800
    v_mfma_f32_16x16x32_bf16 v[16:19], v[80:83], v[136:139], v[16:19]
    ds_read_b128 v[104:107], v204 offset:0
    v_mfma_f32_16x16x32_bf16 v[48:51], v[80:83], v[140:143], v[48:51]
    ds_read_b128 v[108:111], v204 offset:2048
    v_mfma_f32_16x16x32_bf16 v[20:23], v[84:87], v[136:139], v[20:23]
    ds_read_b128 v[112:115], v204 offset:4096
    v_mfma_f32_16x16x32_bf16 v[52:55], v[84:87], v[140:143], v[52:55]
    ds_read_b128 v[116:119], v204 offset:6144
    v_mfma_f32_16x16x32_bf16 v[24:27], v[88:91], v[136:139], v[24:27]
    ds_read_b128 v[120:123], v204 offset:8192
    v_mfma_f32_16x16x32_bf16 v[56:59], v[88:91], v[140:143], v[56:59]
    ds_read_b128 v[124:127], v204 offset:10240
    v_mfma_f32_16x16x32_bf16 v[28:31], v[92:95], v[136:139], v[28:31]
    ds_read_b128 v[128:131], v204 offset:12288
    v_mfma_f32_16x16x32_bf16 v[60:63], v[92:95], v[140:143], v[60:63]
    ds_read_b128 v[132:135], v204 offset:14336
    v_mfma_f32_16x16x32_bf16 v[32:35], v[96:99], v[136:139], v[32:35]
    v_mfma_f32_16x16x32_bf16 v[64:67], v[96:99], v[140:143], v[64:67]
    v_mfma_f32_16x16x32_bf16 v[36:39], v[100:103], v[136:139], v[36:39]
    v_mfma_f32_16x16x32_bf16 v[68:71], v[100:103], v[140:143], v[68:71]
    s_waitcnt lgkmcnt(0)
    s_barrier
    v_add_u32 v203, 0, v238
    v_add_u32 v204, 0, v239
    v_add_u32 v244, 65536, v240
    v_add_u32 v245, 65536, v241
    v_add_u32 v246, 65536, v242
    v_add_u32 v247, 65536, v243
    v_mfma_f32_16x16x32_bf16 v[8:11], v[104:107], v[144:147], v[8:11]
    ds_read_b128 v[72:75], v203 offset:0
    v_mfma_f32_16x16x32_bf16 v[40:43], v[104:107], v[148:151], v[40:43]
    ds_read_b64_tr_b16 v[80:81], v244 offset:0
    v_mfma_f32_16x16x32_bf16 v[12:15], v[108:111], v[144:147], v[12:15]
    ds_read_b64_tr_b16 v[82:83], v244 offset:512
    v_mfma_f32_16x16x32_bf16 v[44:47], v[108:111], v[148:151], v[44:47]
    ds_read_b64_tr_b16 v[84:85], v245 offset:0
    v_mfma_f32_16x16x32_bf16 v[16:19], v[112:115], v[144:147], v[16:19]
    ds_read_b64_tr_b16 v[86:87], v245 offset:512
    v_mfma_f32_16x16x32_bf16 v[48:51], v[112:115], v[148:151], v[48:51]
    ds_read_b64_tr_b16 v[88:89], v246 offset:0
    v_mfma_f32_16x16x32_bf16 v[20:23], v[116:119], v[144:147], v[20:23]
    ds_read_b64_tr_b16 v[90:91], v246 offset:512
    v_mfma_f32_16x16x32_bf16 v[52:55], v[116:119], v[148:151], v[52:55]
    ds_read_b64_tr_b16 v[92:93], v247 offset:0
    v_mfma_f32_16x16x32_bf16 v[24:27], v[120:123], v[144:147], v[24:27]
    ds_read_b64_tr_b16 v[94:95], v247 offset:512
    v_mfma_f32_16x16x32_bf16 v[56:59], v[120:123], v[148:151], v[56:59]
    ds_read_b128 v[76:79], v203 offset:2048
    v_mfma_f32_16x16x32_bf16 v[28:31], v[124:127], v[144:147], v[28:31]
    v_mfma_f32_16x16x32_bf16 v[60:63], v[124:127], v[148:151], v[60:63]
    v_mfma_f32_16x16x32_bf16 v[32:35], v[128:131], v[144:147], v[32:35]
    v_mfma_f32_16x16x32_bf16 v[64:67], v[128:131], v[148:151], v[64:67]
    v_mfma_f32_16x16x32_bf16 v[36:39], v[132:135], v[144:147], v[36:39]
    v_mfma_f32_16x16x32_bf16 v[68:71], v[132:135], v[148:151], v[68:71]
    v_pk_mul_f32 v[184:185], v[8:9], s[96:97]
    v_pk_mul_f32 v[188:189], v[10:11], s[96:97]
    v_pk_mul_f32 v[192:193], v[12:13], s[96:97]
    v_pk_mul_f32 v[196:197], v[14:15], s[96:97]
    v_exp_f32_e64 v184, v184 clamp
    v_exp_f32_e64 v188, v188 clamp
    v_exp_f32_e64 v192, v192 clamp
    v_exp_f32_e64 v196, v196 clamp
    v_exp_f32_e64 v185, v185 clamp
    v_exp_f32_e64 v189, v189 clamp
    v_exp_f32_e64 v193, v193 clamp
    v_exp_f32_e64 v197, v197 clamp
    v_pk_add_f32 v[184:185], v[184:185], s[98:99]
    v_pk_add_f32 v[188:189], v[188:189], s[98:99]
    v_pk_add_f32 v[192:193], v[192:193], s[98:99]
    v_pk_add_f32 v[196:197], v[196:197], s[98:99]
    v_pk_add_f32 v[186:187], v[8:9], v[184:185]
    v_pk_add_f32 v[190:191], v[10:11], v[188:189]
    v_pk_add_f32 v[194:195], v[12:13], v[192:193]
    v_pk_add_f32 v[198:199], v[14:15], v[196:197]
    v_max_f32 v186, v186, v184
    v_max_f32 v190, v190, v188
    v_max_f32 v194, v194, v192
    v_max_f32 v198, v198, v196
    v_max_f32 v187, v187, v185
    v_max_f32 v191, v191, v189
    v_max_f32 v195, v195, v193
    v_max_f32 v199, v199, v197
    v_cvt_pk_bf16_f32 v152, v186, v187
    v_cvt_pk_bf16_f32 v153, v190, v191
    v_cvt_pk_bf16_f32 v154, v194, v195
    v_cvt_pk_bf16_f32 v155, v198, v199
    v_pk_mul_f32 v[184:185], v[16:17], s[96:97]
    v_pk_mul_f32 v[188:189], v[18:19], s[96:97]
    v_pk_mul_f32 v[192:193], v[20:21], s[96:97]
    v_pk_mul_f32 v[196:197], v[22:23], s[96:97]
    v_exp_f32_e64 v184, v184 clamp
    v_exp_f32_e64 v188, v188 clamp
    v_exp_f32_e64 v192, v192 clamp
    v_exp_f32_e64 v196, v196 clamp
    v_exp_f32_e64 v185, v185 clamp
    v_exp_f32_e64 v189, v189 clamp
    v_exp_f32_e64 v193, v193 clamp
    v_exp_f32_e64 v197, v197 clamp
    v_pk_add_f32 v[184:185], v[184:185], s[98:99]
    v_pk_add_f32 v[188:189], v[188:189], s[98:99]
    v_pk_add_f32 v[192:193], v[192:193], s[98:99]
    v_pk_add_f32 v[196:197], v[196:197], s[98:99]
    v_pk_add_f32 v[186:187], v[16:17], v[184:185]
    v_pk_add_f32 v[190:191], v[18:19], v[188:189]
    v_pk_add_f32 v[194:195], v[20:21], v[192:193]
    v_pk_add_f32 v[198:199], v[22:23], v[196:197]
    v_max_f32 v186, v186, v184
    v_max_f32 v190, v190, v188
    v_max_f32 v194, v194, v192
    v_max_f32 v198, v198, v196
    v_max_f32 v187, v187, v185
    v_max_f32 v191, v191, v189
    v_max_f32 v195, v195, v193
    v_max_f32 v199, v199, v197
    v_cvt_pk_bf16_f32 v156, v186, v187
    v_cvt_pk_bf16_f32 v157, v190, v191
    v_cvt_pk_bf16_f32 v158, v194, v195
    v_cvt_pk_bf16_f32 v159, v198, v199
    v_pk_mul_f32 v[184:185], v[24:25], s[96:97]
    v_pk_mul_f32 v[188:189], v[26:27], s[96:97]
    v_pk_mul_f32 v[192:193], v[28:29], s[96:97]
    v_pk_mul_f32 v[196:197], v[30:31], s[96:97]
    v_exp_f32_e64 v184, v184 clamp
    v_exp_f32_e64 v188, v188 clamp
    v_exp_f32_e64 v192, v192 clamp
    v_exp_f32_e64 v196, v196 clamp
    v_exp_f32_e64 v185, v185 clamp
    v_exp_f32_e64 v189, v189 clamp
    v_exp_f32_e64 v193, v193 clamp
    v_exp_f32_e64 v197, v197 clamp
    v_pk_add_f32 v[184:185], v[184:185], s[98:99]
    v_pk_add_f32 v[188:189], v[188:189], s[98:99]
    v_pk_add_f32 v[192:193], v[192:193], s[98:99]
    v_pk_add_f32 v[196:197], v[196:197], s[98:99]
    v_pk_add_f32 v[186:187], v[24:25], v[184:185]
    v_pk_add_f32 v[190:191], v[26:27], v[188:189]
    v_pk_add_f32 v[194:195], v[28:29], v[192:193]
    v_pk_add_f32 v[198:199], v[30:31], v[196:197]
    v_max_f32 v186, v186, v184
    v_max_f32 v190, v190, v188
    v_max_f32 v194, v194, v192
    v_max_f32 v198, v198, v196
    v_max_f32 v187, v187, v185
    v_max_f32 v191, v191, v189
    v_max_f32 v195, v195, v193
    v_max_f32 v199, v199, v197
    v_cvt_pk_bf16_f32 v160, v186, v187
    v_cvt_pk_bf16_f32 v161, v190, v191
    v_cvt_pk_bf16_f32 v162, v194, v195
    v_cvt_pk_bf16_f32 v163, v198, v199
    v_pk_mul_f32 v[184:185], v[32:33], s[96:97]
    v_pk_mul_f32 v[188:189], v[34:35], s[96:97]
    v_pk_mul_f32 v[192:193], v[36:37], s[96:97]
    v_pk_mul_f32 v[196:197], v[38:39], s[96:97]
    v_exp_f32_e64 v184, v184 clamp
    v_exp_f32_e64 v188, v188 clamp
    v_exp_f32_e64 v192, v192 clamp
    v_exp_f32_e64 v196, v196 clamp
    v_exp_f32_e64 v185, v185 clamp
    v_exp_f32_e64 v189, v189 clamp
    v_exp_f32_e64 v193, v193 clamp
    v_exp_f32_e64 v197, v197 clamp
    v_pk_add_f32 v[184:185], v[184:185], s[98:99]
    v_pk_add_f32 v[188:189], v[188:189], s[98:99]
    v_pk_add_f32 v[192:193], v[192:193], s[98:99]
    v_pk_add_f32 v[196:197], v[196:197], s[98:99]
    v_pk_add_f32 v[186:187], v[32:33], v[184:185]
    v_pk_add_f32 v[190:191], v[34:35], v[188:189]
    v_pk_add_f32 v[194:195], v[36:37], v[192:193]
    v_pk_add_f32 v[198:199], v[38:39], v[196:197]
    v_max_f32 v186, v186, v184
    v_max_f32 v190, v190, v188
    v_max_f32 v194, v194, v192
    v_max_f32 v198, v198, v196
    v_max_f32 v187, v187, v185
    v_max_f32 v191, v191, v189
    v_max_f32 v195, v195, v193
    v_max_f32 v199, v199, v197
    v_cvt_pk_bf16_f32 v164, v186, v187
    v_cvt_pk_bf16_f32 v165, v190, v191
    v_cvt_pk_bf16_f32 v166, v194, v195
    v_cvt_pk_bf16_f32 v167, v198, v199
    v_cvt_pk_bf16_f32 v168, v40, v41
    v_cvt_pk_bf16_f32 v169, v42, v43
    v_cvt_pk_bf16_f32 v170, v44, v45
    v_cvt_pk_bf16_f32 v171, v46, v47
    v_cvt_pk_bf16_f32 v172, v48, v49
    v_cvt_pk_bf16_f32 v173, v50, v51
    v_cvt_pk_bf16_f32 v174, v52, v53
    v_cvt_pk_bf16_f32 v175, v54, v55
    v_cvt_pk_bf16_f32 v176, v56, v57
    v_cvt_pk_bf16_f32 v177, v58, v59
    v_cvt_pk_bf16_f32 v178, v60, v61
    v_cvt_pk_bf16_f32 v179, v62, v63
    v_cvt_pk_bf16_f32 v180, v64, v65
    v_cvt_pk_bf16_f32 v181, v66, v67
    v_cvt_pk_bf16_f32 v182, v68, v69
    v_cvt_pk_bf16_f32 v183, v70, v71
    v_mfma_f32_16x16x32_bf16 v[216:219], v[152:155], v[168:171], 0
    v_mfma_f32_16x16x32_bf16 v[220:223], v[152:155], v[208:211], 0
    v_mfma_f32_16x16x32_bf16 v[216:219], v[156:159], v[172:175], v[216:219]
    v_mfma_f32_16x16x32_bf16 v[220:223], v[156:159], v[208:211], v[220:223]
    v_mfma_f32_16x16x32_bf16 v[216:219], v[160:163], v[176:179], v[216:219]
    v_mfma_f32_16x16x32_bf16 v[220:223], v[160:163], v[208:211], v[220:223]
    v_mfma_f32_16x16x32_bf16 v[216:219], v[164:167], v[180:183], v[216:219]
    v_mfma_f32_16x16x32_bf16 v[220:223], v[164:167], v[208:211], v[220:223]
    v_mov_b32 v226, s46
    v_mov_b32 v227, s47
    v_mov_b32 v230, s46
    v_mov_b32 v231, s47
    v_lshlrev_b32 v3, 4, v0
    s_lshl_b32 s76, s7, 2
    s_add_u32 s76, s76, s10
    s_lshl_b32 s11, s76, 14
    s_add_u32 s11, s11, 0x40000
    s_lshl_b32 s12, s76, 10
    s_add_u32 s12, s12, 0xc0000
    s_lshl_b32 s76, s6, 10
    s_add_u32 s76, s76, s11
    s_lshl_b32 s77, s6, 6
    s_add_u32 s77, s77, s12
    v_lshlrev_b32 v4, 4, v2
    v_cvt_pk_bf16_f32 v224, v216, v217
    v_cvt_pk_bf16_f32 v225, v218, v219
    v_cvt_pk_bf16_f32 v228, v220, v221
    v_cvt_pk_bf16_f32 v229, v222, v223
    buffer_store_dwordx4 v[224:227], v3, s[68:71], s76 offen sc1
    v_cmp_eq_u32 vcc, 0, v1
    s_nop 0
    s_and_saveexec_b64 s[78:79], vcc
    buffer_store_dwordx4 v[228:231], v4, s[68:71], s77 offen sc1
    s_mov_b64 exec, s[78:79]
    v_and_b32 v236, 7, v0
    v_lshlrev_b32 v236, 7, v236
    s_lshl_b32 s15, s8, 4
    s_add_u32 s15, s15, s6
    s_lshl_b32 s15, s15, 10
    s_add_u32 s15, s15, 0x8000
    buffer_load_dwordx4 v[232:235], v236, s[68:71], s15 offen sc1
    s_waitcnt lgkmcnt(0)
    v_mfma_f32_16x16x32_bf16 v[8:11], v[80:83], v[72:75], 0
    ds_read_b128 v[104:107], v204 offset:0
    v_mfma_f32_16x16x32_bf16 v[12:15], v[84:87], v[72:75], 0
    ds_read_b64_tr_b16 v[112:113], v244 offset:4096
    v_mfma_f32_16x16x32_bf16 v[16:19], v[88:91], v[72:75], 0
    ds_read_b64_tr_b16 v[114:115], v244 offset:4608
    v_mfma_f32_16x16x32_bf16 v[20:23], v[92:95], v[72:75], 0
    ds_read_b64_tr_b16 v[116:117], v245 offset:4096
    v_mfma_f32_16x16x32_bf16 v[24:27], v[80:83], v[76:79], 0
    ds_read_b64_tr_b16 v[118:119], v245 offset:4608
    v_mfma_f32_16x16x32_bf16 v[28:31], v[84:87], v[76:79], 0
    ds_read_b64_tr_b16 v[120:121], v246 offset:4096
    v_mfma_f32_16x16x32_bf16 v[32:35], v[88:91], v[76:79], 0
    ds_read_b64_tr_b16 v[122:123], v246 offset:4608
    v_mfma_f32_16x16x32_bf16 v[36:39], v[92:95], v[76:79], 0
    ds_read_b64_tr_b16 v[124:125], v247 offset:4096
    ds_read_b64_tr_b16 v[126:127], v247 offset:4608
    ds_read_b128 v[108:111], v204 offset:2048
    s_waitcnt lgkmcnt(0)
    s_barrier
    v_add_u32 v203, 16384, v238
    v_add_u32 v204, 16384, v239
    v_add_u32 v244, 73728, v240
    v_add_u32 v245, 73728, v241
    v_add_u32 v246, 73728, v242
    v_add_u32 v247, 73728, v243
    v_mfma_f32_16x16x32_bf16 v[8:11], v[112:115], v[104:107], v[8:11]
    ds_read_b128 v[72:75], v203 offset:0
    v_mfma_f32_16x16x32_bf16 v[12:15], v[116:119], v[104:107], v[12:15]
    ds_read_b64_tr_b16 v[80:81], v244 offset:0
    v_mfma_f32_16x16x32_bf16 v[16:19], v[120:123], v[104:107], v[16:19]
    ds_read_b64_tr_b16 v[82:83], v244 offset:512
    v_mfma_f32_16x16x32_bf16 v[20:23], v[124:127], v[104:107], v[20:23]
    ds_read_b64_tr_b16 v[84:85], v245 offset:0
    v_mfma_f32_16x16x32_bf16 v[24:27], v[112:115], v[108:111], v[24:27]
    ds_read_b64_tr_b16 v[86:87], v245 offset:512
    v_mfma_f32_16x16x32_bf16 v[28:31], v[116:119], v[108:111], v[28:31]
    ds_read_b64_tr_b16 v[88:89], v246 offset:0
    v_mfma_f32_16x16x32_bf16 v[32:35], v[120:123], v[108:111], v[32:35]
    ds_read_b64_tr_b16 v[90:91], v246 offset:512
    v_mfma_f32_16x16x32_bf16 v[36:39], v[124:127], v[108:111], v[36:39]
    ds_read_b64_tr_b16 v[92:93], v247 offset:0
    ds_read_b64_tr_b16 v[94:95], v247 offset:512
    ds_read_b128 v[76:79], v203 offset:2048
    s_waitcnt lgkmcnt(0)
    v_mfma_f32_16x16x32_bf16 v[8:11], v[80:83], v[72:75], v[8:11]
    ds_read_b128 v[104:107], v204 offset:0
    v_mfma_f32_16x16x32_bf16 v[12:15], v[84:87], v[72:75], v[12:15]
    ds_read_b64_tr_b16 v[112:113], v244 offset:4096
    v_mfma_f32_16x16x32_bf16 v[16:19], v[88:91], v[72:75], v[16:19]
    ds_read_b64_tr_b16 v[114:115], v244 offset:4608
    v_mfma_f32_16x16x32_bf16 v[20:23], v[92:95], v[72:75], v[20:23]
    ds_read_b64_tr_b16 v[116:117], v245 offset:4096
    v_mfma_f32_16x16x32_bf16 v[24:27], v[80:83], v[76:79], v[24:27]
    ds_read_b64_tr_b16 v[118:119], v245 offset:4608
    v_mfma_f32_16x16x32_bf16 v[28:31], v[84:87], v[76:79], v[28:31]
    ds_read_b64_tr_b16 v[120:121], v246 offset:4096
    v_mfma_f32_16x16x32_bf16 v[32:35], v[88:91], v[76:79], v[32:35]
    ds_read_b64_tr_b16 v[122:123], v246 offset:4608
    v_mfma_f32_16x16x32_bf16 v[36:39], v[92:95], v[76:79], v[36:39]
    ds_read_b64_tr_b16 v[124:125], v247 offset:4096
    ds_read_b64_tr_b16 v[126:127], v247 offset:4608
    ds_read_b128 v[108:111], v204 offset:2048
    s_waitcnt lgkmcnt(0)
    s_barrier
    v_add_u32 v203, 32768, v238
    v_add_u32 v204, 32768, v239
    v_add_u32 v244, 81920, v240
    v_add_u32 v245, 81920, v241
    v_add_u32 v246, 81920, v242
    v_add_u32 v247, 81920, v243
    v_mfma_f32_16x16x32_bf16 v[8:11], v[112:115], v[104:107], v[8:11]
    ds_read_b128 v[72:75], v203 offset:0
    v_mfma_f32_16x16x32_bf16 v[12:15], v[116:119], v[104:107], v[12:15]
    ds_read_b64_tr_b16 v[80:81], v244 offset:0
    v_mfma_f32_16x16x32_bf16 v[16:19], v[120:123], v[104:107], v[16:19]
    ds_read_b64_tr_b16 v[82:83], v244 offset:512
    v_mfma_f32_16x16x32_bf16 v[20:23], v[124:127], v[104:107], v[20:23]
    ds_read_b64_tr_b16 v[84:85], v245 offset:0
    v_mfma_f32_16x16x32_bf16 v[24:27], v[112:115], v[108:111], v[24:27]
    ds_read_b64_tr_b16 v[86:87], v245 offset:512
    v_mfma_f32_16x16x32_bf16 v[28:31], v[116:119], v[108:111], v[28:31]
    ds_read_b64_tr_b16 v[88:89], v246 offset:0
    v_mfma_f32_16x16x32_bf16 v[32:35], v[120:123], v[108:111], v[32:35]
    ds_read_b64_tr_b16 v[90:91], v246 offset:512
    v_mfma_f32_16x16x32_bf16 v[36:39], v[124:127], v[108:111], v[36:39]
    ds_read_b64_tr_b16 v[92:93], v247 offset:0
    ds_read_b64_tr_b16 v[94:95], v247 offset:512
    ds_read_b128 v[76:79], v203 offset:2048
    s_waitcnt lgkmcnt(0)
    v_mfma_f32_16x16x32_bf16 v[8:11], v[80:83], v[72:75], v[8:11]
    ds_read_b128 v[104:107], v204 offset:0
    v_mfma_f32_16x16x32_bf16 v[12:15], v[84:87], v[72:75], v[12:15]
    ds_read_b64_tr_b16 v[112:113], v244 offset:4096
    v_mfma_f32_16x16x32_bf16 v[16:19], v[88:91], v[72:75], v[16:19]
    ds_read_b64_tr_b16 v[114:115], v244 offset:4608
    v_mfma_f32_16x16x32_bf16 v[20:23], v[92:95], v[72:75], v[20:23]
    ds_read_b64_tr_b16 v[116:117], v245 offset:4096
    v_mfma_f32_16x16x32_bf16 v[24:27], v[80:83], v[76:79], v[24:27]
    ds_read_b64_tr_b16 v[118:119], v245 offset:4608
    v_mfma_f32_16x16x32_bf16 v[28:31], v[84:87], v[76:79], v[28:31]
    ds_read_b64_tr_b16 v[120:121], v246 offset:4096
    v_mfma_f32_16x16x32_bf16 v[32:35], v[88:91], v[76:79], v[32:35]
    ds_read_b64_tr_b16 v[122:123], v246 offset:4608
    v_mfma_f32_16x16x32_bf16 v[36:39], v[92:95], v[76:79], v[36:39]
    ds_read_b64_tr_b16 v[124:125], v247 offset:4096
    ds_read_b64_tr_b16 v[126:127], v247 offset:4608
    ds_read_b128 v[108:111], v204 offset:2048
    s_waitcnt lgkmcnt(0)
    s_barrier
    v_add_u32 v203, 49152, v238
    v_add_u32 v204, 49152, v239
    v_add_u32 v244, 90112, v240
    v_add_u32 v245, 90112, v241
    v_add_u32 v246, 90112, v242
    v_add_u32 v247, 90112, v243
    v_mfma_f32_16x16x32_bf16 v[8:11], v[112:115], v[104:107], v[8:11]
    ds_read_b128 v[72:75], v203 offset:0
    v_mfma_f32_16x16x32_bf16 v[12:15], v[116:119], v[104:107], v[12:15]
    ds_read_b64_tr_b16 v[80:81], v244 offset:0
    v_mfma_f32_16x16x32_bf16 v[16:19], v[120:123], v[104:107], v[16:19]
    ds_read_b64_tr_b16 v[82:83], v244 offset:512
    v_mfma_f32_16x16x32_bf16 v[20:23], v[124:127], v[104:107], v[20:23]
    ds_read_b64_tr_b16 v[84:85], v245 offset:0
    v_mfma_f32_16x16x32_bf16 v[24:27], v[112:115], v[108:111], v[24:27]
    ds_read_b64_tr_b16 v[86:87], v245 offset:512
    v_mfma_f32_16x16x32_bf16 v[28:31], v[116:119], v[108:111], v[28:31]
    ds_read_b64_tr_b16 v[88:89], v246 offset:0
    v_mfma_f32_16x16x32_bf16 v[32:35], v[120:123], v[108:111], v[32:35]
    ds_read_b64_tr_b16 v[90:91], v246 offset:512
    v_mfma_f32_16x16x32_bf16 v[36:39], v[124:127], v[108:111], v[36:39]
    ds_read_b64_tr_b16 v[92:93], v247 offset:0
    ds_read_b64_tr_b16 v[94:95], v247 offset:512
    ds_read_b128 v[76:79], v203 offset:2048
    s_waitcnt lgkmcnt(0)
    v_mfma_f32_16x16x32_bf16 v[8:11], v[80:83], v[72:75], v[8:11]
    ds_read_b128 v[104:107], v204 offset:0
    v_mfma_f32_16x16x32_bf16 v[12:15], v[84:87], v[72:75], v[12:15]
    ds_read_b64_tr_b16 v[112:113], v244 offset:4096
    v_mfma_f32_16x16x32_bf16 v[16:19], v[88:91], v[72:75], v[16:19]
    ds_read_b64_tr_b16 v[114:115], v244 offset:4608
    v_mfma_f32_16x16x32_bf16 v[20:23], v[92:95], v[72:75], v[20:23]
    ds_read_b64_tr_b16 v[116:117], v245 offset:4096
    v_mfma_f32_16x16x32_bf16 v[24:27], v[80:83], v[76:79], v[24:27]
    ds_read_b64_tr_b16 v[118:119], v245 offset:4608
    v_mfma_f32_16x16x32_bf16 v[28:31], v[84:87], v[76:79], v[28:31]
    ds_read_b64_tr_b16 v[120:121], v246 offset:4096
    v_mfma_f32_16x16x32_bf16 v[32:35], v[88:91], v[76:79], v[32:35]
    ds_read_b64_tr_b16 v[122:123], v246 offset:4608
    v_mfma_f32_16x16x32_bf16 v[36:39], v[92:95], v[76:79], v[36:39]
    ds_read_b64_tr_b16 v[124:125], v247 offset:4096
    ds_read_b64_tr_b16 v[126:127], v247 offset:4608
    ds_read_b128 v[108:111], v204 offset:2048
    s_waitcnt lgkmcnt(0)
    s_barrier
    v_add_u32 v203, 98304, v238
    v_add_u32 v204, 98304, v239
    v_add_u32 v244, 65536, v240
    v_add_u32 v245, 65536, v241
    v_add_u32 v246, 65536, v242
    v_add_u32 v247, 65536, v243
    v_mfma_f32_16x16x32_bf16 v[8:11], v[112:115], v[104:107], v[8:11]
    ds_read_b128 v[72:75], v203 offset:0
    v_mfma_f32_16x16x32_bf16 v[12:15], v[116:119], v[104:107], v[12:15]
    ds_read_b64_tr_b16 v[80:81], v244 offset:0
    v_mfma_f32_16x16x32_bf16 v[16:19], v[120:123], v[104:107], v[16:19]
    ds_read_b64_tr_b16 v[82:83], v244 offset:512
    v_mfma_f32_16x16x32_bf16 v[20:23], v[124:127], v[104:107], v[20:23]
    ds_read_b64_tr_b16 v[84:85], v245 offset:0
    v_mfma_f32_16x16x32_bf16 v[24:27], v[112:115], v[108:111], v[24:27]
    ds_read_b64_tr_b16 v[86:87], v245 offset:512
    v_mfma_f32_16x16x32_bf16 v[28:31], v[116:119], v[108:111], v[28:31]
    ds_read_b64_tr_b16 v[88:89], v246 offset:0
    v_mfma_f32_16x16x32_bf16 v[32:35], v[120:123], v[108:111], v[32:35]
    ds_read_b64_tr_b16 v[90:91], v246 offset:512
    v_mfma_f32_16x16x32_bf16 v[36:39], v[124:127], v[108:111], v[36:39]
    ds_read_b64_tr_b16 v[92:93], v247 offset:0
    ds_read_b64_tr_b16 v[94:95], v247 offset:512
    ds_read_b128 v[76:79], v203 offset:2048
    s_waitcnt lgkmcnt(0)
    v_mfma_f32_16x16x32_bf16 v[8:11], v[80:83], v[72:75], v[8:11]
    ds_read_b128 v[104:107], v204 offset:0
    v_mfma_f32_16x16x32_bf16 v[12:15], v[84:87], v[72:75], v[12:15]
    ds_read_b64_tr_b16 v[112:113], v244 offset:4096
    v_mfma_f32_16x16x32_bf16 v[16:19], v[88:91], v[72:75], v[16:19]
    ds_read_b64_tr_b16 v[114:115], v244 offset:4608
    v_mfma_f32_16x16x32_bf16 v[20:23], v[92:95], v[72:75], v[20:23]
    ds_read_b64_tr_b16 v[116:117], v245 offset:4096
    v_mfma_f32_16x16x32_bf16 v[24:27], v[80:83], v[76:79], v[24:27]
    ds_read_b64_tr_b16 v[118:119], v245 offset:4608
    v_mfma_f32_16x16x32_bf16 v[28:31], v[84:87], v[76:79], v[28:31]
    ds_read_b64_tr_b16 v[120:121], v246 offset:4096
    v_mfma_f32_16x16x32_bf16 v[32:35], v[88:91], v[76:79], v[32:35]
    ds_read_b64_tr_b16 v[122:123], v246 offset:4608
    v_mfma_f32_16x16x32_bf16 v[36:39], v[92:95], v[76:79], v[36:39]
    ds_read_b64_tr_b16 v[124:125], v247 offset:4096
    ds_read_b64_tr_b16 v[126:127], v247 offset:4608
    ds_read_b128 v[108:111], v204 offset:2048
    s_waitcnt lgkmcnt(0)
    s_barrier
    v_add_u32 v203, 114688, v238
    v_add_u32 v204, 114688, v239
    v_add_u32 v244, 73728, v240
    v_add_u32 v245, 73728, v241
    v_add_u32 v246, 73728, v242
    v_add_u32 v247, 73728, v243
    v_mfma_f32_16x16x32_bf16 v[8:11], v[112:115], v[104:107], v[8:11]
    ds_read_b128 v[72:75], v203 offset:0
    v_mfma_f32_16x16x32_bf16 v[12:15], v[116:119], v[104:107], v[12:15]
    ds_read_b64_tr_b16 v[80:81], v244 offset:0
    v_mfma_f32_16x16x32_bf16 v[16:19], v[120:123], v[104:107], v[16:19]
    ds_read_b64_tr_b16 v[82:83], v244 offset:512
    v_mfma_f32_16x16x32_bf16 v[20:23], v[124:127], v[104:107], v[20:23]
    ds_read_b64_tr_b16 v[84:85], v245 offset:0
    v_mfma_f32_16x16x32_bf16 v[24:27], v[112:115], v[108:111], v[24:27]
    ds_read_b64_tr_b16 v[86:87], v245 offset:512
    v_mfma_f32_16x16x32_bf16 v[28:31], v[116:119], v[108:111], v[28:31]
    ds_read_b64_tr_b16 v[88:89], v246 offset:0
    v_mfma_f32_16x16x32_bf16 v[32:35], v[120:123], v[108:111], v[32:35]
    ds_read_b64_tr_b16 v[90:91], v246 offset:512
    v_mfma_f32_16x16x32_bf16 v[36:39], v[124:127], v[108:111], v[36:39]
    ds_read_b64_tr_b16 v[92:93], v247 offset:0
    ds_read_b64_tr_b16 v[94:95], v247 offset:512
    ds_read_b128 v[76:79], v203 offset:2048
    s_waitcnt lgkmcnt(0)
    v_mfma_f32_16x16x32_bf16 v[8:11], v[80:83], v[72:75], v[8:11]
    ds_read_b128 v[104:107], v204 offset:0
    v_mfma_f32_16x16x32_bf16 v[12:15], v[84:87], v[72:75], v[12:15]
    ds_read_b64_tr_b16 v[112:113], v244 offset:4096
    v_mfma_f32_16x16x32_bf16 v[16:19], v[88:91], v[72:75], v[16:19]
    ds_read_b64_tr_b16 v[114:115], v244 offset:4608
    v_mfma_f32_16x16x32_bf16 v[20:23], v[92:95], v[72:75], v[20:23]
    ds_read_b64_tr_b16 v[116:117], v245 offset:4096
    v_mfma_f32_16x16x32_bf16 v[24:27], v[80:83], v[76:79], v[24:27]
    ds_read_b64_tr_b16 v[118:119], v245 offset:4608
    v_mfma_f32_16x16x32_bf16 v[28:31], v[84:87], v[76:79], v[28:31]
    ds_read_b64_tr_b16 v[120:121], v246 offset:4096
    v_mfma_f32_16x16x32_bf16 v[32:35], v[88:91], v[76:79], v[32:35]
    ds_read_b64_tr_b16 v[122:123], v246 offset:4608
    v_mfma_f32_16x16x32_bf16 v[36:39], v[92:95], v[76:79], v[36:39]
    ds_read_b64_tr_b16 v[124:125], v247 offset:4096
    ds_read_b64_tr_b16 v[126:127], v247 offset:4608
    ds_read_b128 v[108:111], v204 offset:2048
    s_waitcnt lgkmcnt(0)
    s_barrier
    v_add_u32 v203, 131072, v238
    v_add_u32 v204, 131072, v239
    v_add_u32 v244, 81920, v240
    v_add_u32 v245, 81920, v241
    v_add_u32 v246, 81920, v242
    v_add_u32 v247, 81920, v243
    v_mfma_f32_16x16x32_bf16 v[8:11], v[112:115], v[104:107], v[8:11]
    ds_read_b128 v[72:75], v203 offset:0
    v_mfma_f32_16x16x32_bf16 v[12:15], v[116:119], v[104:107], v[12:15]
    ds_read_b64_tr_b16 v[80:81], v244 offset:0
    v_mfma_f32_16x16x32_bf16 v[16:19], v[120:123], v[104:107], v[16:19]
    ds_read_b64_tr_b16 v[82:83], v244 offset:512
    v_mfma_f32_16x16x32_bf16 v[20:23], v[124:127], v[104:107], v[20:23]
    ds_read_b64_tr_b16 v[84:85], v245 offset:0
    v_mfma_f32_16x16x32_bf16 v[24:27], v[112:115], v[108:111], v[24:27]
    ds_read_b64_tr_b16 v[86:87], v245 offset:512
    v_mfma_f32_16x16x32_bf16 v[28:31], v[116:119], v[108:111], v[28:31]
    ds_read_b64_tr_b16 v[88:89], v246 offset:0
    v_mfma_f32_16x16x32_bf16 v[32:35], v[120:123], v[108:111], v[32:35]
    ds_read_b64_tr_b16 v[90:91], v246 offset:512
    v_mfma_f32_16x16x32_bf16 v[36:39], v[124:127], v[108:111], v[36:39]
    ds_read_b64_tr_b16 v[92:93], v247 offset:0
    ds_read_b64_tr_b16 v[94:95], v247 offset:512
    ds_read_b128 v[76:79], v203 offset:2048
    s_waitcnt lgkmcnt(0)
    v_mfma_f32_16x16x32_bf16 v[8:11], v[80:83], v[72:75], v[8:11]
    ds_read_b128 v[104:107], v204 offset:0
    v_mfma_f32_16x16x32_bf16 v[12:15], v[84:87], v[72:75], v[12:15]
    ds_read_b64_tr_b16 v[112:113], v244 offset:4096
    v_mfma_f32_16x16x32_bf16 v[16:19], v[88:91], v[72:75], v[16:19]
    ds_read_b64_tr_b16 v[114:115], v244 offset:4608
    v_mfma_f32_16x16x32_bf16 v[20:23], v[92:95], v[72:75], v[20:23]
    ds_read_b64_tr_b16 v[116:117], v245 offset:4096
    v_mfma_f32_16x16x32_bf16 v[24:27], v[80:83], v[76:79], v[24:27]
    ds_read_b64_tr_b16 v[118:119], v245 offset:4608
    v_mfma_f32_16x16x32_bf16 v[28:31], v[84:87], v[76:79], v[28:31]
    ds_read_b64_tr_b16 v[120:121], v246 offset:4096
    v_mfma_f32_16x16x32_bf16 v[32:35], v[88:91], v[76:79], v[32:35]
    ds_read_b64_tr_b16 v[122:123], v246 offset:4608
    v_mfma_f32_16x16x32_bf16 v[36:39], v[92:95], v[76:79], v[36:39]
    ds_read_b64_tr_b16 v[124:125], v247 offset:4096
    ds_read_b64_tr_b16 v[126:127], v247 offset:4608
    ds_read_b128 v[108:111], v204 offset:2048
    s_waitcnt lgkmcnt(0)
    v_add_u32 v203, 147456, v238
    v_add_u32 v204, 147456, v239
    v_add_u32 v244, 90112, v240
    v_add_u32 v245, 90112, v241
    v_add_u32 v246, 90112, v242
    v_add_u32 v247, 90112, v243
    v_mfma_f32_16x16x32_bf16 v[8:11], v[112:115], v[104:107], v[8:11]
    ds_read_b128 v[72:75], v203 offset:0
    v_mfma_f32_16x16x32_bf16 v[12:15], v[116:119], v[104:107], v[12:15]
    ds_read_b64_tr_b16 v[80:81], v244 offset:0
    v_mfma_f32_16x16x32_bf16 v[16:19], v[120:123], v[104:107], v[16:19]
    ds_read_b64_tr_b16 v[82:83], v244 offset:512
    v_mfma_f32_16x16x32_bf16 v[20:23], v[124:127], v[104:107], v[20:23]
    ds_read_b64_tr_b16 v[84:85], v245 offset:0
    v_mfma_f32_16x16x32_bf16 v[24:27], v[112:115], v[108:111], v[24:27]
    ds_read_b64_tr_b16 v[86:87], v245 offset:512
    v_mfma_f32_16x16x32_bf16 v[28:31], v[116:119], v[108:111], v[28:31]
    ds_read_b64_tr_b16 v[88:89], v246 offset:0
    v_mfma_f32_16x16x32_bf16 v[32:35], v[120:123], v[108:111], v[32:35]
    ds_read_b64_tr_b16 v[90:91], v246 offset:512
    v_mfma_f32_16x16x32_bf16 v[36:39], v[124:127], v[108:111], v[36:39]
    ds_read_b64_tr_b16 v[92:93], v247 offset:0
    ds_read_b64_tr_b16 v[94:95], v247 offset:512
    ds_read_b128 v[76:79], v203 offset:2048
    s_waitcnt lgkmcnt(0)
    v_mfma_f32_16x16x32_bf16 v[8:11], v[80:83], v[72:75], v[8:11]
    ds_read_b128 v[104:107], v204 offset:0
    v_mfma_f32_16x16x32_bf16 v[12:15], v[84:87], v[72:75], v[12:15]
    ds_read_b64_tr_b16 v[112:113], v244 offset:4096
    v_mfma_f32_16x16x32_bf16 v[16:19], v[88:91], v[72:75], v[16:19]
    ds_read_b64_tr_b16 v[114:115], v244 offset:4608
    v_mfma_f32_16x16x32_bf16 v[20:23], v[92:95], v[72:75], v[20:23]
    ds_read_b64_tr_b16 v[116:117], v245 offset:4096
    v_mfma_f32_16x16x32_bf16 v[24:27], v[80:83], v[76:79], v[24:27]
    ds_read_b64_tr_b16 v[118:119], v245 offset:4608
    v_mfma_f32_16x16x32_bf16 v[28:31], v[84:87], v[76:79], v[28:31]
    ds_read_b64_tr_b16 v[120:121], v246 offset:4096
    v_mfma_f32_16x16x32_bf16 v[32:35], v[88:91], v[76:79], v[32:35]
    ds_read_b64_tr_b16 v[122:123], v246 offset:4608
    v_mfma_f32_16x16x32_bf16 v[36:39], v[92:95], v[76:79], v[36:39]
    ds_read_b64_tr_b16 v[124:125], v247 offset:4096
    ds_read_b64_tr_b16 v[126:127], v247 offset:4608
    ds_read_b128 v[108:111], v204 offset:2048
    s_waitcnt lgkmcnt(0)
    v_mfma_f32_16x16x32_bf16 v[8:11], v[112:115], v[104:107], v[8:11]
    v_mfma_f32_16x16x32_bf16 v[12:15], v[116:119], v[104:107], v[12:15]
    v_mfma_f32_16x16x32_bf16 v[16:19], v[120:123], v[104:107], v[16:19]
    v_mfma_f32_16x16x32_bf16 v[20:23], v[124:127], v[104:107], v[20:23]
    v_mfma_f32_16x16x32_bf16 v[24:27], v[112:115], v[108:111], v[24:27]
    v_mfma_f32_16x16x32_bf16 v[28:31], v[116:119], v[108:111], v[28:31]
    v_mfma_f32_16x16x32_bf16 v[32:35], v[120:123], v[108:111], v[32:35]
    v_mfma_f32_16x16x32_bf16 v[36:39], v[124:127], v[108:111], v[36:39]
    s_nop 0
    v_pk_mul_f32 v[184:185], v[8:9], s[96:97]
    v_pk_mul_f32 v[188:189], v[10:11], s[96:97]
    v_pk_mul_f32 v[192:193], v[12:13], s[96:97]
    v_pk_mul_f32 v[196:197], v[14:15], s[96:97]
    v_exp_f32_e64 v184, v184 clamp
    v_exp_f32_e64 v188, v188 clamp
    v_exp_f32_e64 v192, v192 clamp
    v_exp_f32_e64 v196, v196 clamp
    v_exp_f32_e64 v185, v185 clamp
    v_exp_f32_e64 v189, v189 clamp
    v_exp_f32_e64 v193, v193 clamp
    v_exp_f32_e64 v197, v197 clamp
    v_pk_add_f32 v[184:185], v[184:185], s[98:99]
    v_pk_add_f32 v[188:189], v[188:189], s[98:99]
    v_pk_add_f32 v[192:193], v[192:193], s[98:99]
    v_pk_add_f32 v[196:197], v[196:197], s[98:99]
    v_pk_add_f32 v[186:187], v[8:9], v[184:185]
    v_pk_add_f32 v[190:191], v[10:11], v[188:189]
    v_pk_add_f32 v[194:195], v[12:13], v[192:193]
    v_pk_add_f32 v[198:199], v[14:15], v[196:197]
    v_max_f32 v186, v186, v184
    v_max_f32 v190, v190, v188
    v_max_f32 v194, v194, v192
    v_max_f32 v198, v198, v196
    v_max_f32 v187, v187, v185
    v_max_f32 v191, v191, v189
    v_max_f32 v195, v195, v193
    v_max_f32 v199, v199, v197
    v_cvt_pk_bf16_f32 v152, v186, v187
    v_cvt_pk_bf16_f32 v153, v190, v191
    v_cvt_pk_bf16_f32 v154, v194, v195
    v_cvt_pk_bf16_f32 v155, v198, v199
    v_pk_mul_f32 v[184:185], v[16:17], s[96:97]
    v_pk_mul_f32 v[188:189], v[18:19], s[96:97]
    v_pk_mul_f32 v[192:193], v[20:21], s[96:97]
    v_pk_mul_f32 v[196:197], v[22:23], s[96:97]
    v_exp_f32_e64 v184, v184 clamp
    v_exp_f32_e64 v188, v188 clamp
    v_exp_f32_e64 v192, v192 clamp
    v_exp_f32_e64 v196, v196 clamp
    v_exp_f32_e64 v185, v185 clamp
    v_exp_f32_e64 v189, v189 clamp
    v_exp_f32_e64 v193, v193 clamp
    v_exp_f32_e64 v197, v197 clamp
    v_pk_add_f32 v[184:185], v[184:185], s[98:99]
    v_pk_add_f32 v[188:189], v[188:189], s[98:99]
    v_pk_add_f32 v[192:193], v[192:193], s[98:99]
    v_pk_add_f32 v[196:197], v[196:197], s[98:99]
    v_pk_add_f32 v[186:187], v[16:17], v[184:185]
    v_pk_add_f32 v[190:191], v[18:19], v[188:189]
    v_pk_add_f32 v[194:195], v[20:21], v[192:193]
    v_pk_add_f32 v[198:199], v[22:23], v[196:197]
    v_max_f32 v186, v186, v184
    v_max_f32 v190, v190, v188
    v_max_f32 v194, v194, v192
    v_max_f32 v198, v198, v196
    v_max_f32 v187, v187, v185
    v_max_f32 v191, v191, v189
    v_max_f32 v195, v195, v193
    v_max_f32 v199, v199, v197
    v_cvt_pk_bf16_f32 v156, v186, v187
    v_cvt_pk_bf16_f32 v157, v190, v191
    v_cvt_pk_bf16_f32 v158, v194, v195
    v_cvt_pk_bf16_f32 v159, v198, v199
    v_pk_mul_f32 v[184:185], v[24:25], s[96:97]
    v_pk_mul_f32 v[188:189], v[26:27], s[96:97]
    v_pk_mul_f32 v[192:193], v[28:29], s[96:97]
    v_pk_mul_f32 v[196:197], v[30:31], s[96:97]
    v_exp_f32_e64 v184, v184 clamp
    v_exp_f32_e64 v188, v188 clamp
    v_exp_f32_e64 v192, v192 clamp
    v_exp_f32_e64 v196, v196 clamp
    v_exp_f32_e64 v185, v185 clamp
    v_exp_f32_e64 v189, v189 clamp
    v_exp_f32_e64 v193, v193 clamp
    v_exp_f32_e64 v197, v197 clamp
    v_pk_add_f32 v[184:185], v[184:185], s[98:99]
    v_pk_add_f32 v[188:189], v[188:189], s[98:99]
    v_pk_add_f32 v[192:193], v[192:193], s[98:99]
    v_pk_add_f32 v[196:197], v[196:197], s[98:99]
    v_pk_add_f32 v[186:187], v[24:25], v[184:185]
    v_pk_add_f32 v[190:191], v[26:27], v[188:189]
    v_pk_add_f32 v[194:195], v[28:29], v[192:193]
    v_pk_add_f32 v[198:199], v[30:31], v[196:197]
    v_max_f32 v186, v186, v184
    v_max_f32 v190, v190, v188
    v_max_f32 v194, v194, v192
    v_max_f32 v198, v198, v196
    v_max_f32 v187, v187, v185
    v_max_f32 v191, v191, v189
    v_max_f32 v195, v195, v193
    v_max_f32 v199, v199, v197
    v_cvt_pk_bf16_f32 v160, v186, v187
    v_cvt_pk_bf16_f32 v161, v190, v191
    v_cvt_pk_bf16_f32 v162, v194, v195
    v_cvt_pk_bf16_f32 v163, v198, v199
    v_pk_mul_f32 v[184:185], v[32:33], s[96:97]
    v_pk_mul_f32 v[188:189], v[34:35], s[96:97]
    v_pk_mul_f32 v[192:193], v[36:37], s[96:97]
    v_pk_mul_f32 v[196:197], v[38:39], s[96:97]
    v_exp_f32_e64 v184, v184 clamp
    v_exp_f32_e64 v188, v188 clamp
    v_exp_f32_e64 v192, v192 clamp
    v_exp_f32_e64 v196, v196 clamp
    v_exp_f32_e64 v185, v185 clamp
    v_exp_f32_e64 v189, v189 clamp
    v_exp_f32_e64 v193, v193 clamp
    v_exp_f32_e64 v197, v197 clamp
    v_pk_add_f32 v[184:185], v[184:185], s[98:99]
    v_pk_add_f32 v[188:189], v[188:189], s[98:99]
    v_pk_add_f32 v[192:193], v[192:193], s[98:99]
    v_pk_add_f32 v[196:197], v[196:197], s[98:99]
    v_pk_add_f32 v[186:187], v[32:33], v[184:185]
    v_pk_add_f32 v[190:191], v[34:35], v[188:189]
    v_pk_add_f32 v[194:195], v[36:37], v[192:193]
    v_pk_add_f32 v[198:199], v[38:39], v[196:197]
    v_max_f32 v186, v186, v184
    v_max_f32 v190, v190, v188
    v_max_f32 v194, v194, v192
    v_max_f32 v198, v198, v196
    v_max_f32 v187, v187, v185
    v_max_f32 v191, v191, v189
    v_max_f32 v195, v195, v193
    v_max_f32 v199, v199, v197
    v_cvt_pk_bf16_f32 v164, v186, v187
    v_cvt_pk_bf16_f32 v165, v190, v191
    v_cvt_pk_bf16_f32 v166, v194, v195
    v_cvt_pk_bf16_f32 v167, v198, v199
    s_waitcnt vmcnt(0)
    s_mov_b32 s3, 0
L_A_xchk:
    v_cmp_ne_u64 vcc, s[46:47], v[234:235]
    s_nop 0
    s_cmp_eq_u64 vcc, 0
    s_cbranch_scc1 L_A_xok
    s_add_u32 s3, s3, 1
    s_cmp_ge_u32 s3, 1048576
    s_cbranch_scc1 L_A_xok
    buffer_load_dwordx4 v[232:235], v236, s[68:71], s15 offen sc1
    s_waitcnt vmcnt(0)
    s_branch L_A_xchk
L_A_xok:
    s_getreg_b32 s76, hwreg(HW_REG_XCC_ID)
    s_and_b32 s76, s76, 15
    v_cmp_ne_u32 vcc, s76, v232
    s_mov_b32 s14, 0
    s_cmp_eq_u64 vcc, 0
    s_cselect_b32 s14, 1, 0
    s_barrier
    v_add_u32 v70, 98304, v3
    ds_read_b128 v[136:139], v70 offset:0
    ds_read_b128 v[140:143], v70 offset:1024
    ds_read_b128 v[144:147], v70 offset:2048
    ds_read_b128 v[148:151], v70 offset:3072
    v_mov_b32 v68, 0x358637bd
    s_lshl_b32 s76, s6, 4
    s_lshl_b32 s77, s7, 1
    s_add_u32 s76, s76, s77
    s_lshl_b32 s76, s76, 13
    s_lshl_b32 s77, s10, 11
    s_add_u32 s76, s76, s77
    s_add_u32 s76, s76, 0x100000
    s_lshl_b32 s15, s6, 8
    s_lshl_b32 s77, s7, 5
    s_add_u32 s15, s15, s77
    s_lshl_b32 s77, s10, 3
    s_add_u32 s15, s15, s77
    s_add_u32 s15, s15, 0x1000
    v_mov_b32 v4, s46
    v_mov_b32 v5, s47
    v_mov_b32 v6, 0
    s_waitcnt lgkmcnt(0)
    v_mfma_f32_16x16x16_bf16 v[72:75], v[136:137], v[152:153], 0
    v_mfma_f32_16x16x16_bf16 v[104:107], v[138:139], v[152:153], 0
    v_mfma_f32_16x16x16_bf16 v[76:79], v[140:141], v[154:155], 0
    v_mfma_f32_16x16x16_bf16 v[108:111], v[142:143], v[154:155], 0
    v_mfma_f32_16x16x16_bf16 v[80:83], v[144:145], v[156:157], 0
    v_mfma_f32_16x16x16_bf16 v[112:115], v[146:147], v[156:157], 0
    v_mfma_f32_16x16x16_bf16 v[84:87], v[148:149], v[158:159], 0
    v_mfma_f32_16x16x16_bf16 v[116:119], v[150:151], v[158:159], 0
    v_mfma_f32_16x16x16_bf16 v[88:91], v[136:137], v[160:161], 0
    v_mfma_f32_16x16x16_bf16 v[120:123], v[138:139], v[160:161], 0
    v_mfma_f32_16x16x16_bf16 v[92:95], v[140:141], v[162:163], 0
    v_mfma_f32_16x16x16_bf16 v[124:127], v[142:143], v[162:163], 0
    v_mfma_f32_16x16x16_bf16 v[96:99], v[144:145], v[164:165], 0
    v_mfma_f32_16x16x16_bf16 v[128:131], v[146:147], v[164:165], 0
    v_mfma_f32_16x16x16_bf16 v[100:103], v[148:149], v[166:167], 0
    v_mfma_f32_16x16x16_bf16 v[132:135], v[150:151], v[166:167], 0
    v_add_f32 v104, v104, v68
    v_add_f32 v108, v108, v68
    v_add_f32 v112, v112, v68
    v_add_f32 v116, v116, v68
    v_add_f32 v120, v120, v68
    v_add_f32 v124, v124, v68
    v_add_f32 v128, v128, v68
    s_nop 0
    v_add_f32 v132, v132, v68
    v_rcp_f32 v104, v104
    v_rcp_f32 v108, v108
    v_rcp_f32 v112, v112
    v_rcp_f32 v116, v116
    v_rcp_f32 v120, v120
    v_rcp_f32 v124, v124
    v_rcp_f32 v128, v128
    v_rcp_f32 v132, v132
    v_mul_f32 v72, v72, v104
    v_mul_f32 v73, v73, v104
    v_mul_f32 v74, v74, v104
    v_mul_f32 v75, v75, v104
    v_mul_f32 v76, v76, v108
    v_mul_f32 v77, v77, v108
    v_mul_f32 v78, v78, v108
    v_mul_f32 v79, v79, v108
    v_mul_f32 v80, v80, v112
    v_mul_f32 v81, v81, v112
    v_mul_f32 v82, v82, v112
    v_mul_f32 v83, v83, v112
    v_mul_f32 v84, v84, v116
    v_mul_f32 v85, v85, v116
    v_mul_f32 v86, v86, v116
    v_mul_f32 v87, v87, v116
    v_mul_f32 v88, v88, v120
    v_mul_f32 v89, v89, v120
    v_mul_f32 v90, v90, v120
    v_mul_f32 v91, v91, v120
    v_mul_f32 v92, v92, v124
    v_mul_f32 v93, v93, v124
    v_mul_f32 v94, v94, v124
    v_mul_f32 v95, v95, v124
    v_mul_f32 v96, v96, v128
    v_mul_f32 v97, v97, v128
    v_mul_f32 v98, v98, v128
    v_mul_f32 v99, v99, v128
    v_mul_f32 v100, v100, v132
    v_mul_f32 v101, v101, v132
    v_mul_f32 v102, v102, v132
    v_mul_f32 v103, v103, v132
    v_cvt_pk_bf16_f32 v40, v72, v73
    v_cvt_pk_bf16_f32 v41, v74, v75
    v_cvt_pk_bf16_f32 v42, v76, v77
    v_cvt_pk_bf16_f32 v43, v78, v79
    v_cvt_pk_bf16_f32 v44, v80, v81
    v_cvt_pk_bf16_f32 v45, v82, v83
    v_cvt_pk_bf16_f32 v46, v84, v85
    v_cvt_pk_bf16_f32 v47, v86, v87
    v_cvt_pk_bf16_f32 v48, v88, v89
    v_cvt_pk_bf16_f32 v49, v90, v91
    v_cvt_pk_bf16_f32 v50, v92, v93
    v_cvt_pk_bf16_f32 v51, v94, v95
    v_cvt_pk_bf16_f32 v52, v96, v97
    v_cvt_pk_bf16_f32 v53, v98, v99
    v_cvt_pk_bf16_f32 v54, v100, v101
    v_cvt_pk_bf16_f32 v55, v102, v103
    s_cmp_eq_u32 s14, 1
    s_cbranch_scc0 L_Ao_slow
    buffer_store_dwordx4 v[40:43], v3, s[68:71], s76 offen offset:0 nt
    buffer_store_dwordx4 v[48:51], v3, s[68:71], s76 offen offset:1024 nt
    s_add_u32 s76, s76, 8192
    buffer_store_dwordx4 v[44:47], v3, s[68:71], s76 offen offset:0 nt
    buffer_store_dwordx4 v[52:55], v3, s[68:71], s76 offen offset:1024 nt
L_Ao_join:
    s_cmp_eq_u32 s14, 1
    s_cbranch_scc0 L_Af_slow
    s_waitcnt vmcnt(0)
    s_mov_b64 exec, 1
    buffer_store_dwordx2 v[4:5], v6, s[68:71], s15 offen nt
    s_mov_b64 exec, -1
L_Af_join:
    v_lshrrev_b32 v212, 2, v1
    v_lshl_add_u32 v212, v2, 2, v212
    v_and_b32 v213, 6, v212
    v_bfe_u32 v214, v1, 1, 1
    v_xor_b32 v213, v213, v214
    v_lshlrev_b32 v213, 4, v213
    v_lshl_add_u32 v212, v212, 7, v213
    v_and_b32 v214, 1, v1
    v_lshl_add_u32 v200, v214, 3, v212
    v_xor_b32 v201, 32, v200
    v_xor_b32 v202, 64, v200
    v_xor_b32 v203, 96, v200
    s_lshl_b32 s76, s10, 11
    v_add_u32 v7, s76, v3
    s_lshl_b32 s12, s6, 17
    s_add_u32 s12, s12, 0x100000
    s_barrier
    s_add_u32 s78, s12, 0
    buffer_load_dwordx4 v[72:75], v7, s[68:71], s78 offen sc1
    buffer_load_dwordx4 v[76:79], v7, s[68:71], s78 offen offset:1024 sc1
    s_add_u32 s78, s12, 8192
    buffer_load_dwordx4 v[80:83], v7, s[68:71], s78 offen sc1
    buffer_load_dwordx4 v[84:87], v7, s[68:71], s78 offen offset:1024 sc1
    s_add_u32 s78, s12, 16384
    buffer_load_dwordx4 v[88:91], v7, s[68:71], s78 offen sc1
    buffer_load_dwordx4 v[92:95], v7, s[68:71], s78 offen offset:1024 sc1
    s_add_u32 s78, s12, 24576
    buffer_load_dwordx4 v[96:99], v7, s[68:71], s78 offen sc1
    buffer_load_dwordx4 v[100:103], v7, s[68:71], s78 offen offset:1024 sc1
    s_add_u32 s78, s12, 32768
    buffer_load_dwordx4 v[104:107], v7, s[68:71], s78 offen sc1
    buffer_load_dwordx4 v[108:111], v7, s[68:71], s78 offen offset:1024 sc1
    s_add_u32 s78, s12, 40960
    buffer_load_dwordx4 v[112:115], v7, s[68:71], s78 offen sc1
    buffer_load_dwordx4 v[116:119], v7, s[68:71], s78 offen offset:1024 sc1
    s_add_u32 s78, s12, 49152
    buffer_load_dwordx4 v[120:123], v7, s[68:71], s78 offen sc1
    buffer_load_dwordx4 v[124:127], v7, s[68:71], s78 offen offset:1024 sc1
    s_add_u32 s78, s12, 57344
    buffer_load_dwordx4 v[128:131], v7, s[68:71], s78 offen sc1
    buffer_load_dwordx4 v[132:135], v7, s[68:71], s78 offen offset:1024 sc1
    ds_read_b64_tr_b16 v[40:41], v200 offset:0
    ds_read_b64_tr_b16 v[42:43], v200 offset:2048
    ds_read_b64_tr_b16 v[44:45], v201 offset:0
    ds_read_b64_tr_b16 v[46:47], v201 offset:2048
    ds_read_b64_tr_b16 v[48:49], v202 offset:0
    ds_read_b64_tr_b16 v[50:51], v202 offset:2048
    ds_read_b64_tr_b16 v[52:53], v203 offset:0
    ds_read_b64_tr_b16 v[54:55], v203 offset:2048
    s_waitcnt vmcnt(14) lgkmcnt(0)
    v_mfma_f32_16x16x32_bf16 v[8:11], v[72:75], v[40:43], 0
    ds_read_b64_tr_b16 v[56:57], v200 offset:4096
    ds_read_b64_tr_b16 v[58:59], v200 offset:6144
    v_mfma_f32_16x16x32_bf16 v[12:15], v[72:75], v[44:47], 0
    ds_read_b64_tr_b16 v[60:61], v201 offset:4096
    ds_read_b64_tr_b16 v[62:63], v201 offset:6144
    v_mfma_f32_16x16x32_bf16 v[16:19], v[72:75], v[48:51], 0
    ds_read_b64_tr_b16 v[64:65], v202 offset:4096
    ds_read_b64_tr_b16 v[66:67], v202 offset:6144
    v_mfma_f32_16x16x32_bf16 v[20:23], v[72:75], v[52:55], 0
    ds_read_b64_tr_b16 v[68:69], v203 offset:4096
    ds_read_b64_tr_b16 v[70:71], v203 offset:6144
    v_mfma_f32_16x16x32_bf16 v[24:27], v[76:79], v[40:43], 0
    s_add_u32 s78, s12, 65536
    buffer_load_dwordx4 v[136:139], v7, s[68:71], s78 offen sc1
    v_mfma_f32_16x16x32_bf16 v[28:31], v[76:79], v[44:47], 0
    buffer_load_dwordx4 v[140:143], v7, s[68:71], s78 offen offset:1024 sc1
    v_mfma_f32_16x16x32_bf16 v[32:35], v[76:79], v[48:51], 0
    v_mfma_f32_16x16x32_bf16 v[36:39], v[76:79], v[52:55], 0
    s_waitcnt vmcnt(14) lgkmcnt(0)
    v_mfma_f32_16x16x32_bf16 v[8:11], v[80:83], v[56:59], v[8:11]
    ds_read_b64_tr_b16 v[40:41], v200 offset:8192
    ds_read_b64_tr_b16 v[42:43], v200 offset:10240
    v_mfma_f32_16x16x32_bf16 v[12:15], v[80:83], v[60:63], v[12:15]
    ds_read_b64_tr_b16 v[44:45], v201 offset:8192
    ds_read_b64_tr_b16 v[46:47], v201 offset:10240
    v_mfma_f32_16x16x32_bf16 v[16:19], v[80:83], v[64:67], v[16:19]
    ds_read_b64_tr_b16 v[48:49], v202 offset:8192
    ds_read_b64_tr_b16 v[50:51], v202 offset:10240
    v_mfma_f32_16x16x32_bf16 v[20:23], v[80:83], v[68:71], v[20:23]
    ds_read_b64_tr_b16 v[52:53], v203 offset:8192
    ds_read_b64_tr_b16 v[54:55], v203 offset:10240
    v_mfma_f32_16x16x32_bf16 v[24:27], v[84:87], v[56:59], v[24:27]
    s_add_u32 s78, s12, 73728
    buffer_load_dwordx4 v[144:147], v7, s[68:71], s78 offen sc1
    v_mfma_f32_16x16x32_bf16 v[28:31], v[84:87], v[60:63], v[28:31]
    buffer_load_dwordx4 v[148:151], v7, s[68:71], s78 offen offset:1024 sc1
    v_mfma_f32_16x16x32_bf16 v[32:35], v[84:87], v[64:67], v[32:35]
    v_mfma_f32_16x16x32_bf16 v[36:39], v[84:87], v[68:71], v[36:39]
    s_waitcnt vmcnt(14) lgkmcnt(0)
    v_mfma_f32_16x16x32_bf16 v[8:11], v[88:91], v[40:43], v[8:11]
    ds_read_b64_tr_b16 v[56:57], v200 offset:12288
    ds_read_b64_tr_b16 v[58:59], v200 offset:14336
    v_mfma_f32_16x16x32_bf16 v[12:15], v[88:91], v[44:47], v[12:15]
    ds_read_b64_tr_b16 v[60:61], v201 offset:12288
    ds_read_b64_tr_b16 v[62:63], v201 offset:14336
    v_mfma_f32_16x16x32_bf16 v[16:19], v[88:91], v[48:51], v[16:19]
    ds_read_b64_tr_b16 v[64:65], v202 offset:12288
    ds_read_b64_tr_b16 v[66:67], v202 offset:14336
    v_mfma_f32_16x16x32_bf16 v[20:23], v[88:91], v[52:55], v[20:23]
    ds_read_b64_tr_b16 v[68:69], v203 offset:12288
    ds_read_b64_tr_b16 v[70:71], v203 offset:14336
    v_mfma_f32_16x16x32_bf16 v[24:27], v[92:95], v[40:43], v[24:27]
    s_add_u32 s78, s12, 81920
    buffer_load_dwordx4 v[152:155], v7, s[68:71], s78 offen sc1
    v_mfma_f32_16x16x32_bf16 v[28:31], v[92:95], v[44:47], v[28:31]
    buffer_load_dwordx4 v[156:159], v7, s[68:71], s78 offen offset:1024 sc1
    v_mfma_f32_16x16x32_bf16 v[32:35], v[92:95], v[48:51], v[32:35]
    v_mfma_f32_16x16x32_bf16 v[36:39], v[92:95], v[52:55], v[36:39]
    s_waitcnt vmcnt(14) lgkmcnt(0)
    v_mfma_f32_16x16x32_bf16 v[8:11], v[96:99], v[56:59], v[8:11]
    ds_read_b64_tr_b16 v[40:41], v200 offset:16384
    ds_read_b64_tr_b16 v[42:43], v200 offset:18432
    v_mfma_f32_16x16x32_bf16 v[12:15], v[96:99], v[60:63], v[12:15]
    ds_read_b64_tr_b16 v[44:45], v201 offset:16384
    ds_read_b64_tr_b16 v[46:47], v201 offset:18432
    v_mfma_f32_16x16x32_bf16 v[16:19], v[96:99], v[64:67], v[16:19]
    ds_read_b64_tr_b16 v[48:49], v202 offset:16384
    ds_read_b64_tr_b16 v[50:51], v202 offset:18432
    v_mfma_f32_16x16x32_bf16 v[20:23], v[96:99], v[68:71], v[20:23]
    ds_read_b64_tr_b16 v[52:53], v203 offset:16384
    ds_read_b64_tr_b16 v[54:55], v203 offset:18432
    v_mfma_f32_16x16x32_bf16 v[24:27], v[100:103], v[56:59], v[24:27]
    s_add_u32 s78, s12, 90112
    buffer_load_dwordx4 v[160:163], v7, s[68:71], s78 offen sc1
    v_mfma_f32_16x16x32_bf16 v[28:31], v[100:103], v[60:63], v[28:31]
    buffer_load_dwordx4 v[164:167], v7, s[68:71], s78 offen offset:1024 sc1
    v_mfma_f32_16x16x32_bf16 v[32:35], v[100:103], v[64:67], v[32:35]
    v_mfma_f32_16x16x32_bf16 v[36:39], v[100:103], v[68:71], v[36:39]
    s_waitcnt vmcnt(14) lgkmcnt(0)
    v_mfma_f32_16x16x32_bf16 v[8:11], v[104:107], v[40:43], v[8:11]
    ds_read_b64_tr_b16 v[56:57], v200 offset:20480
    ds_read_b64_tr_b16 v[58:59], v200 offset:22528
    v_mfma_f32_16x16x32_bf16 v[12:15], v[104:107], v[44:47], v[12:15]
    ds_read_b64_tr_b16 v[60:61], v201 offset:20480
    ds_read_b64_tr_b16 v[62:63], v201 offset:22528
    v_mfma_f32_16x16x32_bf16 v[16:19], v[104:107], v[48:51], v[16:19]
    ds_read_b64_tr_b16 v[64:65], v202 offset:20480
    ds_read_b64_tr_b16 v[66:67], v202 offset:22528
    v_mfma_f32_16x16x32_bf16 v[20:23], v[104:107], v[52:55], v[20:23]
    ds_read_b64_tr_b16 v[68:69], v203 offset:20480
    ds_read_b64_tr_b16 v[70:71], v203 offset:22528
    v_mfma_f32_16x16x32_bf16 v[24:27], v[108:111], v[40:43], v[24:27]
    s_add_u32 s78, s12, 98304
    buffer_load_dwordx4 v[168:171], v7, s[68:71], s78 offen sc1
    v_mfma_f32_16x16x32_bf16 v[28:31], v[108:111], v[44:47], v[28:31]
    buffer_load_dwordx4 v[172:175], v7, s[68:71], s78 offen offset:1024 sc1
    v_mfma_f32_16x16x32_bf16 v[32:35], v[108:111], v[48:51], v[32:35]
    v_mfma_f32_16x16x32_bf16 v[36:39], v[108:111], v[52:55], v[36:39]
    s_waitcnt vmcnt(14) lgkmcnt(0)
    v_mfma_f32_16x16x32_bf16 v[8:11], v[112:115], v[56:59], v[8:11]
    ds_read_b64_tr_b16 v[40:41], v200 offset:24576
    ds_read_b64_tr_b16 v[42:43], v200 offset:26624
    v_mfma_f32_16x16x32_bf16 v[12:15], v[112:115], v[60:63], v[12:15]
    ds_read_b64_tr_b16 v[44:45], v201 offset:24576
    ds_read_b64_tr_b16 v[46:47], v201 offset:26624
    v_mfma_f32_16x16x32_bf16 v[16:19], v[112:115], v[64:67], v[16:19]
    ds_read_b64_tr_b16 v[48:49], v202 offset:24576
    ds_read_b64_tr_b16 v[50:51], v202 offset:26624
    v_mfma_f32_16x16x32_bf16 v[20:23], v[112:115], v[68:71], v[20:23]
    ds_read_b64_tr_b16 v[52:53], v203 offset:24576
    ds_read_b64_tr_b16 v[54:55], v203 offset:26624
    v_mfma_f32_16x16x32_bf16 v[24:27], v[116:119], v[56:59], v[24:27]
    s_add_u32 s78, s12, 106496
    buffer_load_dwordx4 v[176:179], v7, s[68:71], s78 offen sc1
    v_mfma_f32_16x16x32_bf16 v[28:31], v[116:119], v[60:63], v[28:31]
    buffer_load_dwordx4 v[180:183], v7, s[68:71], s78 offen offset:1024 sc1
    v_mfma_f32_16x16x32_bf16 v[32:35], v[116:119], v[64:67], v[32:35]
    v_mfma_f32_16x16x32_bf16 v[36:39], v[116:119], v[68:71], v[36:39]
    s_waitcnt vmcnt(14) lgkmcnt(0)
    v_mfma_f32_16x16x32_bf16 v[8:11], v[120:123], v[40:43], v[8:11]
    ds_read_b64_tr_b16 v[56:57], v200 offset:28672
    ds_read_b64_tr_b16 v[58:59], v200 offset:30720
    v_mfma_f32_16x16x32_bf16 v[12:15], v[120:123], v[44:47], v[12:15]
    ds_read_b64_tr_b16 v[60:61], v201 offset:28672
    ds_read_b64_tr_b16 v[62:63], v201 offset:30720
    v_mfma_f32_16x16x32_bf16 v[16:19], v[120:123], v[48:51], v[16:19]
    ds_read_b64_tr_b16 v[64:65], v202 offset:28672
    ds_read_b64_tr_b16 v[66:67], v202 offset:30720
    v_mfma_f32_16x16x32_bf16 v[20:23], v[120:123], v[52:55], v[20:23]
    ds_read_b64_tr_b16 v[68:69], v203 offset:28672
    ds_read_b64_tr_b16 v[70:71], v203 offset:30720
    v_mfma_f32_16x16x32_bf16 v[24:27], v[124:127], v[40:43], v[24:27]
    s_add_u32 s78, s12, 114688
    buffer_load_dwordx4 v[184:187], v7, s[68:71], s78 offen sc1
    v_mfma_f32_16x16x32_bf16 v[28:31], v[124:127], v[44:47], v[28:31]
    buffer_load_dwordx4 v[188:191], v7, s[68:71], s78 offen offset:1024 sc1
    v_mfma_f32_16x16x32_bf16 v[32:35], v[124:127], v[48:51], v[32:35]
    v_mfma_f32_16x16x32_bf16 v[36:39], v[124:127], v[52:55], v[36:39]
    s_waitcnt vmcnt(14) lgkmcnt(0)
    v_mfma_f32_16x16x32_bf16 v[8:11], v[128:131], v[56:59], v[8:11]
    ds_read_b64_tr_b16 v[40:41], v200 offset:32768
    ds_read_b64_tr_b16 v[42:43], v200 offset:34816
    v_mfma_f32_16x16x32_bf16 v[12:15], v[128:131], v[60:63], v[12:15]
    ds_read_b64_tr_b16 v[44:45], v201 offset:32768
    ds_read_b64_tr_b16 v[46:47], v201 offset:34816
    v_mfma_f32_16x16x32_bf16 v[16:19], v[128:131], v[64:67], v[16:19]
    ds_read_b64_tr_b16 v[48:49], v202 offset:32768
    ds_read_b64_tr_b16 v[50:51], v202 offset:34816
    v_mfma_f32_16x16x32_bf16 v[20:23], v[128:131], v[68:71], v[20:23]
    ds_read_b64_tr_b16 v[52:53], v203 offset:32768
    ds_read_b64_tr_b16 v[54:55], v203 offset:34816
    v_mfma_f32_16x16x32_bf16 v[24:27], v[132:135], v[56:59], v[24:27]
    s_add_u32 s78, s12, 122880
    buffer_load_dwordx4 v[192:195], v7, s[68:71], s78 offen sc1
    v_mfma_f32_16x16x32_bf16 v[28:31], v[132:135], v[60:63], v[28:31]
    buffer_load_dwordx4 v[196:199], v7, s[68:71], s78 offen offset:1024 sc1
    v_mfma_f32_16x16x32_bf16 v[32:35], v[132:135], v[64:67], v[32:35]
    v_mfma_f32_16x16x32_bf16 v[36:39], v[132:135], v[68:71], v[36:39]
    s_waitcnt vmcnt(14) lgkmcnt(0)
    v_mfma_f32_16x16x32_bf16 v[8:11], v[136:139], v[40:43], v[8:11]
    ds_read_b64_tr_b16 v[56:57], v200 offset:36864
    v_mfma_f32_16x16x32_bf16 v[12:15], v[136:139], v[44:47], v[12:15]
    ds_read_b64_tr_b16 v[58:59], v200 offset:38912
    v_mfma_f32_16x16x32_bf16 v[16:19], v[136:139], v[48:51], v[16:19]
    ds_read_b64_tr_b16 v[60:61], v201 offset:36864
    v_mfma_f32_16x16x32_bf16 v[20:23], v[136:139], v[52:55], v[20:23]
    ds_read_b64_tr_b16 v[62:63], v201 offset:38912
    v_mfma_f32_16x16x32_bf16 v[24:27], v[140:143], v[40:43], v[24:27]
    ds_read_b64_tr_b16 v[64:65], v202 offset:36864
    v_mfma_f32_16x16x32_bf16 v[28:31], v[140:143], v[44:47], v[28:31]
    ds_read_b64_tr_b16 v[66:67], v202 offset:38912
    v_mfma_f32_16x16x32_bf16 v[32:35], v[140:143], v[48:51], v[32:35]
    ds_read_b64_tr_b16 v[68:69], v203 offset:36864
    v_mfma_f32_16x16x32_bf16 v[36:39], v[140:143], v[52:55], v[36:39]
    ds_read_b64_tr_b16 v[70:71], v203 offset:38912
    s_waitcnt vmcnt(12) lgkmcnt(0)
    v_mfma_f32_16x16x32_bf16 v[8:11], v[144:147], v[56:59], v[8:11]
    ds_read_b64_tr_b16 v[40:41], v200 offset:40960
    v_mfma_f32_16x16x32_bf16 v[12:15], v[144:147], v[60:63], v[12:15]
    ds_read_b64_tr_b16 v[42:43], v200 offset:43008
    v_mfma_f32_16x16x32_bf16 v[16:19], v[144:147], v[64:67], v[16:19]
    ds_read_b64_tr_b16 v[44:45], v201 offset:40960
    v_mfma_f32_16x16x32_bf16 v[20:23], v[144:147], v[68:71], v[20:23]
    ds_read_b64_tr_b16 v[46:47], v201 offset:43008
    v_mfma_f32_16x16x32_bf16 v[24:27], v[148:151], v[56:59], v[24:27]
    ds_read_b64_tr_b16 v[48:49], v202 offset:40960
    v_mfma_f32_16x16x32_bf16 v[28:31], v[148:151], v[60:63], v[28:31]
    ds_read_b64_tr_b16 v[50:51], v202 offset:43008
    v_mfma_f32_16x16x32_bf16 v[32:35], v[148:151], v[64:67], v[32:35]
    ds_read_b64_tr_b16 v[52:53], v203 offset:40960
    v_mfma_f32_16x16x32_bf16 v[36:39], v[148:151], v[68:71], v[36:39]
    ds_read_b64_tr_b16 v[54:55], v203 offset:43008
    s_waitcnt vmcnt(10) lgkmcnt(0)
    v_mfma_f32_16x16x32_bf16 v[8:11], v[152:155], v[40:43], v[8:11]
    ds_read_b64_tr_b16 v[56:57], v200 offset:45056
    v_mfma_f32_16x16x32_bf16 v[12:15], v[152:155], v[44:47], v[12:15]
    ds_read_b64_tr_b16 v[58:59], v200 offset:47104
    v_mfma_f32_16x16x32_bf16 v[16:19], v[152:155], v[48:51], v[16:19]
    ds_read_b64_tr_b16 v[60:61], v201 offset:45056
    v_mfma_f32_16x16x32_bf16 v[20:23], v[152:155], v[52:55], v[20:23]
    ds_read_b64_tr_b16 v[62:63], v201 offset:47104
    v_mfma_f32_16x16x32_bf16 v[24:27], v[156:159], v[40:43], v[24:27]
    ds_read_b64_tr_b16 v[64:65], v202 offset:45056
    v_mfma_f32_16x16x32_bf16 v[28:31], v[156:159], v[44:47], v[28:31]
    ds_read_b64_tr_b16 v[66:67], v202 offset:47104
    v_mfma_f32_16x16x32_bf16 v[32:35], v[156:159], v[48:51], v[32:35]
    ds_read_b64_tr_b16 v[68:69], v203 offset:45056
    v_mfma_f32_16x16x32_bf16 v[36:39], v[156:159], v[52:55], v[36:39]
    ds_read_b64_tr_b16 v[70:71], v203 offset:47104
    s_waitcnt vmcnt(8) lgkmcnt(0)
    v_mfma_f32_16x16x32_bf16 v[8:11], v[160:163], v[56:59], v[8:11]
    ds_read_b64_tr_b16 v[40:41], v200 offset:49152
    v_mfma_f32_16x16x32_bf16 v[12:15], v[160:163], v[60:63], v[12:15]
    ds_read_b64_tr_b16 v[42:43], v200 offset:51200
    v_mfma_f32_16x16x32_bf16 v[16:19], v[160:163], v[64:67], v[16:19]
    ds_read_b64_tr_b16 v[44:45], v201 offset:49152
    v_mfma_f32_16x16x32_bf16 v[20:23], v[160:163], v[68:71], v[20:23]
    ds_read_b64_tr_b16 v[46:47], v201 offset:51200
    v_mfma_f32_16x16x32_bf16 v[24:27], v[164:167], v[56:59], v[24:27]
    ds_read_b64_tr_b16 v[48:49], v202 offset:49152
    v_mfma_f32_16x16x32_bf16 v[28:31], v[164:167], v[60:63], v[28:31]
    ds_read_b64_tr_b16 v[50:51], v202 offset:51200
    v_mfma_f32_16x16x32_bf16 v[32:35], v[164:167], v[64:67], v[32:35]
    ds_read_b64_tr_b16 v[52:53], v203 offset:49152
    v_mfma_f32_16x16x32_bf16 v[36:39], v[164:167], v[68:71], v[36:39]
    ds_read_b64_tr_b16 v[54:55], v203 offset:51200
    s_waitcnt vmcnt(6) lgkmcnt(0)
    v_mfma_f32_16x16x32_bf16 v[8:11], v[168:171], v[40:43], v[8:11]
    ds_read_b64_tr_b16 v[56:57], v200 offset:53248
    v_mfma_f32_16x16x32_bf16 v[12:15], v[168:171], v[44:47], v[12:15]
    ds_read_b64_tr_b16 v[58:59], v200 offset:55296
    v_mfma_f32_16x16x32_bf16 v[16:19], v[168:171], v[48:51], v[16:19]
    ds_read_b64_tr_b16 v[60:61], v201 offset:53248
    v_mfma_f32_16x16x32_bf16 v[20:23], v[168:171], v[52:55], v[20:23]
    ds_read_b64_tr_b16 v[62:63], v201 offset:55296
    v_mfma_f32_16x16x32_bf16 v[24:27], v[172:175], v[40:43], v[24:27]
    ds_read_b64_tr_b16 v[64:65], v202 offset:53248
    v_mfma_f32_16x16x32_bf16 v[28:31], v[172:175], v[44:47], v[28:31]
    ds_read_b64_tr_b16 v[66:67], v202 offset:55296
    v_mfma_f32_16x16x32_bf16 v[32:35], v[172:175], v[48:51], v[32:35]
    ds_read_b64_tr_b16 v[68:69], v203 offset:53248
    v_mfma_f32_16x16x32_bf16 v[36:39], v[172:175], v[52:55], v[36:39]
    ds_read_b64_tr_b16 v[70:71], v203 offset:55296
    s_waitcnt vmcnt(4) lgkmcnt(0)
    v_mfma_f32_16x16x32_bf16 v[8:11], v[176:179], v[56:59], v[8:11]
    ds_read_b64_tr_b16 v[40:41], v200 offset:57344
    v_mfma_f32_16x16x32_bf16 v[12:15], v[176:179], v[60:63], v[12:15]
    ds_read_b64_tr_b16 v[42:43], v200 offset:59392
    v_mfma_f32_16x16x32_bf16 v[16:19], v[176:179], v[64:67], v[16:19]
    ds_read_b64_tr_b16 v[44:45], v201 offset:57344
    v_mfma_f32_16x16x32_bf16 v[20:23], v[176:179], v[68:71], v[20:23]
    ds_read_b64_tr_b16 v[46:47], v201 offset:59392
    v_mfma_f32_16x16x32_bf16 v[24:27], v[180:183], v[56:59], v[24:27]
    ds_read_b64_tr_b16 v[48:49], v202 offset:57344
    v_mfma_f32_16x16x32_bf16 v[28:31], v[180:183], v[60:63], v[28:31]
    ds_read_b64_tr_b16 v[50:51], v202 offset:59392
    v_mfma_f32_16x16x32_bf16 v[32:35], v[180:183], v[64:67], v[32:35]
    ds_read_b64_tr_b16 v[52:53], v203 offset:57344
    v_mfma_f32_16x16x32_bf16 v[36:39], v[180:183], v[68:71], v[36:39]
    ds_read_b64_tr_b16 v[54:55], v203 offset:59392
    s_waitcnt vmcnt(2) lgkmcnt(0)
    v_mfma_f32_16x16x32_bf16 v[8:11], v[184:187], v[40:43], v[8:11]
    ds_read_b64_tr_b16 v[56:57], v200 offset:61440
    v_mfma_f32_16x16x32_bf16 v[12:15], v[184:187], v[44:47], v[12:15]
    ds_read_b64_tr_b16 v[58:59], v200 offset:63488
    v_mfma_f32_16x16x32_bf16 v[16:19], v[184:187], v[48:51], v[16:19]
    ds_read_b64_tr_b16 v[60:61], v201 offset:61440
    v_mfma_f32_16x16x32_bf16 v[20:23], v[184:187], v[52:55], v[20:23]
    ds_read_b64_tr_b16 v[62:63], v201 offset:63488
    v_mfma_f32_16x16x32_bf16 v[24:27], v[188:191], v[40:43], v[24:27]
    ds_read_b64_tr_b16 v[64:65], v202 offset:61440
    v_mfma_f32_16x16x32_bf16 v[28:31], v[188:191], v[44:47], v[28:31]
    ds_read_b64_tr_b16 v[66:67], v202 offset:63488
    v_mfma_f32_16x16x32_bf16 v[32:35], v[188:191], v[48:51], v[32:35]
    ds_read_b64_tr_b16 v[68:69], v203 offset:61440
    v_mfma_f32_16x16x32_bf16 v[36:39], v[188:191], v[52:55], v[36:39]
    ds_read_b64_tr_b16 v[70:71], v203 offset:63488
    s_waitcnt vmcnt(0) lgkmcnt(0)
    v_mfma_f32_16x16x32_bf16 v[8:11], v[192:195], v[56:59], v[8:11]
    v_mfma_f32_16x16x32_bf16 v[12:15], v[192:195], v[60:63], v[12:15]
    v_mfma_f32_16x16x32_bf16 v[16:19], v[192:195], v[64:67], v[16:19]
    v_mfma_f32_16x16x32_bf16 v[20:23], v[192:195], v[68:71], v[20:23]
    v_mfma_f32_16x16x32_bf16 v[24:27], v[196:199], v[56:59], v[24:27]
    v_mfma_f32_16x16x32_bf16 v[28:31], v[196:199], v[60:63], v[28:31]
    v_mfma_f32_16x16x32_bf16 v[32:35], v[196:199], v[64:67], v[32:35]
    v_mfma_f32_16x16x32_bf16 v[36:39], v[196:199], v[68:71], v[36:39]
    v_lshlrev_b32 v204, 14, v2
    v_lshl_add_u32 v204, v1, 2, v204
    s_lshl_b32 s13, s6, 19
    s_lshl_b32 s76, s10, 17
    s_add_u32 s13, s13, s76
    s_lshl_b32 s76, s7, 8
    s_add_u32 s13, s13, s76
    s_add_u32 s76, s13, 0
    buffer_store_dword v8, v204, s[72:75], s76 offen offset:0 nt
    buffer_store_dword v12, v204, s[72:75], s76 offen offset:64 nt
    buffer_store_dword v16, v204, s[72:75], s76 offen offset:128 nt
    buffer_store_dword v20, v204, s[72:75], s76 offen offset:192 nt
    s_add_u32 s76, s13, 4096
    buffer_store_dword v9, v204, s[72:75], s76 offen offset:0 nt
    buffer_store_dword v13, v204, s[72:75], s76 offen offset:64 nt
    buffer_store_dword v17, v204, s[72:75], s76 offen offset:128 nt
    buffer_store_dword v21, v204, s[72:75], s76 offen offset:192 nt
    s_add_u32 s76, s13, 8192
    buffer_store_dword v10, v204, s[72:75], s76 offen offset:0 nt
    buffer_store_dword v14, v204, s[72:75], s76 offen offset:64 nt
    buffer_store_dword v18, v204, s[72:75], s76 offen offset:128 nt
    buffer_store_dword v22, v204, s[72:75], s76 offen offset:192 nt
    s_add_u32 s76, s13, 12288
    buffer_store_dword v11, v204, s[72:75], s76 offen offset:0 nt
    buffer_store_dword v15, v204, s[72:75], s76 offen offset:64 nt
    buffer_store_dword v19, v204, s[72:75], s76 offen offset:128 nt
    buffer_store_dword v23, v204, s[72:75], s76 offen offset:192 nt
    s_add_u32 s76, s13, 65536
    buffer_store_dword v24, v204, s[72:75], s76 offen offset:0 nt
    buffer_store_dword v28, v204, s[72:75], s76 offen offset:64 nt
    buffer_store_dword v32, v204, s[72:75], s76 offen offset:128 nt
    buffer_store_dword v36, v204, s[72:75], s76 offen offset:192 nt
    s_add_u32 s76, s13, 69632
    buffer_store_dword v25, v204, s[72:75], s76 offen offset:0 nt
    buffer_store_dword v29, v204, s[72:75], s76 offen offset:64 nt
    buffer_store_dword v33, v204, s[72:75], s76 offen offset:128 nt
    buffer_store_dword v37, v204, s[72:75], s76 offen offset:192 nt
    s_add_u32 s76, s13, 73728
    buffer_store_dword v26, v204, s[72:75], s76 offen offset:0 nt
    buffer_store_dword v30, v204, s[72:75], s76 offen offset:64 nt
    buffer_store_dword v34, v204, s[72:75], s76 offen offset:128 nt
    buffer_store_dword v38, v204, s[72:75], s76 offen offset:192 nt
    s_add_u32 s76, s13, 77824
    buffer_store_dword v27, v204, s[72:75], s76 offen offset:0 nt
    buffer_store_dword v31, v204, s[72:75], s76 offen offset:64 nt
    buffer_store_dword v35, v204, s[72:75], s76 offen offset:128 nt
    buffer_store_dword v39, v204, s[72:75], s76 offen offset:192 nt
    s_endpgm
L_computeB:
    s_setprio 1
    v_and_b32 v1, 15, v0
    v_lshrrev_b32 v2, 4, v0
    s_lshl_b32 s76, s7, 7
    s_lshl_b32 s77, s10, 5
    s_add_u32 s76, s76, s77
    v_lshlrev_b32 v216, 3, v2
    v_add_u32 v216, s76, v216
    v_and_b32 v217, 7, v1
    v_xor_b32 v217, v217, v2
    v_lshlrev_b32 v217, 4, v217
    v_lshl_add_u32 v208, v1, 7, v217
    v_xor_b32 v209, 64, v208
    v_add_u32 v210, 0x10000, v208
    v_add_u32 v211, 0x10000, v209
    v_and_b32 v217, 1, v1
    v_lshrrev_b32 v218, 2, v1
    v_bfe_u32 v219, v1, 1, 1
    v_lshl_add_u32 v220, v217, 4, v219
    v_lshl_add_u32 v220, v218, 2, v220
    v_lshl_add_u32 v221, v218, 1, v217
    v_xor_b32 v221, v221, v2
    v_lshlrev_b32 v221, 4, v221
    v_lshl_add_u32 v220, v220, 7, v221
    s_lshl_b32 s77, s10, 12
    s_add_u32 s77, s77, 16384
    v_add_u32 v212, s77, v220
    v_xor_b32 v213, 64, v212
    v_add_u32 v214, 0x10000, v212
    v_add_u32 v215, 0x10000, v213
    s_waitcnt lgkmcnt(0)
    global_load_dwordx2 v[220:221], v216, s[24:25]
    global_load_dwordx2 v[222:223], v216, s[26:27]
    global_load_dwordx2 v[224:225], v216, s[36:37]
    s_load_dwordx2 s[46:47], s[44:45], 0
    s_mov_b32 s68, s44
    s_mov_b32 s69, s45
    s_mov_b32 s70, 0x1000000
    s_mov_b32 s71, 0x00020000
    s_mov_b32 s48, s22
    s_mov_b32 s49, s23
    s_mov_b32 s50, 0x200000
    s_mov_b32 s51, 0x00020000
    s_mov_b32 s72, s40
    s_mov_b32 s73, s41
    s_mov_b32 s74, 0x800000
    s_mov_b32 s75, 0x00020000
    s_mov_b32 s96, 0x3fb8aa3b
    s_mov_b32 s97, 0x3e22f983
    s_waitcnt vmcnt(0)
    v_lshlrev_b32 v56, 16, v220
    v_lshlrev_b32 v60, 16, v222
    v_lshlrev_b32 v228, 16, v224
    v_and_b32 v57, 0xffff0000, v220
    v_and_b32 v61, 0xffff0000, v222
    v_and_b32 v229, 0xffff0000, v224
    v_lshlrev_b32 v58, 16, v221
    v_lshlrev_b32 v62, 16, v223
    v_lshlrev_b32 v230, 16, v225
    v_and_b32 v59, 0xffff0000, v221
    v_and_b32 v63, 0xffff0000, v223
    v_and_b32 v231, 0xffff0000, v225
    v_mul_f32 v228, s96, v228
    v_mul_f32 v229, s96, v229
    v_mul_f32 v230, s96, v230
    v_mul_f32 v231, s96, v231
    v_exp_f32 v228, v228
    v_exp_f32 v229, v229
    v_exp_f32 v230, v230
    v_exp_f32 v231, v231
    v_cvt_pk_bf16_f32 v228, v228, v228
    v_cvt_pk_bf16_f32 v229, v229, v229
    v_cvt_pk_bf16_f32 v230, v230, v230
    v_cvt_pk_bf16_f32 v231, v231, v231
    v_and_b32 v228, 0xffff0000, v228
    v_and_b32 v229, 0xffff0000, v229
    v_and_b32 v230, 0xffff0000, v230
    v_and_b32 v231, 0xffff0000, v231
    v_mul_f32 v48, v228, v56
    v_mul_f32 v52, v228, v60
    v_mul_f32 v49, v229, v57
    v_mul_f32 v53, v229, v61
    v_mul_f32 v50, v230, v58
    v_mul_f32 v54, v230, v62
    v_mul_f32 v51, v231, v59
    v_mul_f32 v55, v231, v63
    v_mul_f32 v48, s96, v48
    v_mul_f32 v52, s97, v52
    v_mul_f32 v49, s96, v49
    v_mul_f32 v53, s97, v53
    v_mul_f32 v50, s96, v50
    v_mul_f32 v54, s97, v54
    v_mul_f32 v51, s96, v51
    v_mul_f32 v55, s97, v55
    v_exp_f32 v232, v48
    v_exp_f32 v235, v49
    v_exp_f32 v238, v50
    v_exp_f32 v241, v51
    v_fract_f32 v233, v52
    v_fract_f32 v236, v53
    v_fract_f32 v239, v54
    v_fract_f32 v242, v55
    v_cos_f32 v234, v233
    v_cos_f32 v237, v236
    v_cos_f32 v240, v239
    v_cos_f32 v243, v242
    v_sin_f32 v233, v233
    v_sin_f32 v236, v236
    v_sin_f32 v239, v239
    v_sin_f32 v242, v242
    v_mul_f32 v8, v232, v234
    v_mul_f32 v10, v235, v237
    v_mul_f32 v12, v238, v240
    v_mul_f32 v14, v241, v243
    v_mul_f32 v9, v232, v233
    v_mul_f32 v11, v235, v236
    v_mul_f32 v13, v238, v239
    v_mul_f32 v15, v241, v242
    v_pk_mul_f32 v[248:249], v[8:9], v[8:9] op_sel_hi:[1,0]
    v_pk_mul_f32 v[250:251], v[10:11], v[10:11] op_sel_hi:[1,0]
    v_pk_mul_f32 v[252:253], v[12:13], v[12:13] op_sel_hi:[1,0]
    v_pk_mul_f32 v[254:255], v[14:15], v[14:15] op_sel_hi:[1,0]
    v_pk_fma_f32 v[232:233], v[8:9], v[8:9], v[248:249] op_sel:[1,1,0] op_sel_hi:[0,1,1] neg_lo:[0,1,0]
    v_pk_fma_f32 v[234:235], v[10:11], v[10:11], v[250:251] op_sel:[1,1,0] op_sel_hi:[0,1,1] neg_lo:[0,1,0]
    v_pk_fma_f32 v[236:237], v[12:13], v[12:13], v[252:253] op_sel:[1,1,0] op_sel_hi:[0,1,1] neg_lo:[0,1,0]
    v_pk_fma_f32 v[238:239], v[14:15], v[14:15], v[254:255] op_sel:[1,1,0] op_sel_hi:[0,1,1] neg_lo:[0,1,0]
    v_pk_mul_f32 v[248:249], v[232:233], v[232:233] op_sel_hi:[1,0]
    v_pk_mul_f32 v[250:251], v[234:235], v[234:235] op_sel_hi:[1,0]
    v_pk_mul_f32 v[252:253], v[236:237], v[236:237] op_sel_hi:[1,0]
    v_pk_mul_f32 v[254:255], v[238:239], v[238:239] op_sel_hi:[1,0]
    v_pk_fma_f32 v[240:241], v[232:233], v[232:233], v[248:249] op_sel:[1,1,0] op_sel_hi:[0,1,1] neg_lo:[0,1,0]
    v_pk_fma_f32 v[242:243], v[234:235], v[234:235], v[250:251] op_sel:[1,1,0] op_sel_hi:[0,1,1] neg_lo:[0,1,0]
    v_pk_fma_f32 v[244:245], v[236:237], v[236:237], v[252:253] op_sel:[1,1,0] op_sel_hi:[0,1,1] neg_lo:[0,1,0]
    v_pk_fma_f32 v[246:247], v[238:239], v[238:239], v[254:255] op_sel:[1,1,0] op_sel_hi:[0,1,1] neg_lo:[0,1,0]
    v_pk_mul_f32 v[248:249], v[240:241], v[240:241] op_sel_hi:[1,0]
    v_pk_mul_f32 v[250:251], v[242:243], v[242:243] op_sel_hi:[1,0]
    v_pk_mul_f32 v[252:253], v[244:245], v[244:245] op_sel_hi:[1,0]
    v_pk_mul_f32 v[254:255], v[246:247], v[246:247] op_sel_hi:[1,0]
    v_pk_fma_f32 v[16:17], v[240:241], v[240:241], v[248:249] op_sel:[1,1,0] op_sel_hi:[0,1,1] neg_lo:[0,1,0]
    v_pk_fma_f32 v[18:19], v[242:243], v[242:243], v[250:251] op_sel:[1,1,0] op_sel_hi:[0,1,1] neg_lo:[0,1,0]
    v_pk_fma_f32 v[20:21], v[244:245], v[244:245], v[252:253] op_sel:[1,1,0] op_sel_hi:[0,1,1] neg_lo:[0,1,0]
    v_pk_fma_f32 v[22:23], v[246:247], v[246:247], v[254:255] op_sel:[1,1,0] op_sel_hi:[0,1,1] neg_lo:[0,1,0]
    v_pk_mul_f32 v[248:249], v[16:17], v[16:17] op_sel_hi:[1,0]
    v_pk_mul_f32 v[250:251], v[18:19], v[18:19] op_sel_hi:[1,0]
    v_pk_mul_f32 v[252:253], v[20:21], v[20:21] op_sel_hi:[1,0]
    v_pk_mul_f32 v[254:255], v[22:23], v[22:23] op_sel_hi:[1,0]
    v_pk_fma_f32 v[24:25], v[16:17], v[16:17], v[248:249] op_sel:[1,1,0] op_sel_hi:[0,1,1] neg_lo:[0,1,0]
    v_pk_fma_f32 v[26:27], v[18:19], v[18:19], v[250:251] op_sel:[1,1,0] op_sel_hi:[0,1,1] neg_lo:[0,1,0]
    v_pk_fma_f32 v[28:29], v[20:21], v[20:21], v[252:253] op_sel:[1,1,0] op_sel_hi:[0,1,1] neg_lo:[0,1,0]
    v_pk_fma_f32 v[30:31], v[22:23], v[22:23], v[254:255] op_sel:[1,1,0] op_sel_hi:[0,1,1] neg_lo:[0,1,0]
    v_pk_mul_f32 v[248:249], v[24:25], v[24:25] op_sel_hi:[1,0]
    v_pk_mul_f32 v[250:251], v[26:27], v[26:27] op_sel_hi:[1,0]
    v_pk_mul_f32 v[252:253], v[28:29], v[28:29] op_sel_hi:[1,0]
    v_pk_mul_f32 v[254:255], v[30:31], v[30:31] op_sel_hi:[1,0]
    v_pk_fma_f32 v[32:33], v[24:25], v[24:25], v[248:249] op_sel:[1,1,0] op_sel_hi:[0,1,1] neg_lo:[0,1,0]
    v_pk_fma_f32 v[34:35], v[26:27], v[26:27], v[250:251] op_sel:[1,1,0] op_sel_hi:[0,1,1] neg_lo:[0,1,0]
    v_pk_fma_f32 v[36:37], v[28:29], v[28:29], v[252:253] op_sel:[1,1,0] op_sel_hi:[0,1,1] neg_lo:[0,1,0]
    v_pk_fma_f32 v[38:39], v[30:31], v[30:31], v[254:255] op_sel:[1,1,0] op_sel_hi:[0,1,1] neg_lo:[0,1,0]
    v_pk_mul_f32 v[248:249], v[32:33], v[32:33] op_sel_hi:[1,0]
    v_pk_mul_f32 v[250:251], v[34:35], v[34:35] op_sel_hi:[1,0]
    v_pk_mul_f32 v[252:253], v[36:37], v[36:37] op_sel_hi:[1,0]
    v_pk_mul_f32 v[254:255], v[38:39], v[38:39] op_sel_hi:[1,0]
    v_pk_fma_f32 v[40:41], v[32:33], v[32:33], v[248:249] op_sel:[1,1,0] op_sel_hi:[0,1,1] neg_lo:[0,1,0]
    v_pk_fma_f32 v[42:43], v[34:35], v[34:35], v[250:251] op_sel:[1,1,0] op_sel_hi:[0,1,1] neg_lo:[0,1,0]
    v_pk_fma_f32 v[44:45], v[36:37], v[36:37], v[252:253] op_sel:[1,1,0] op_sel_hi:[0,1,1] neg_lo:[0,1,0]
    v_pk_fma_f32 v[46:47], v[38:39], v[38:39], v[254:255] op_sel:[1,1,0] op_sel_hi:[0,1,1] neg_lo:[0,1,0]
    v_lshlrev_b32 v253, 3, v1
    s_lshl_b32 s76, s7, 7
    v_add_u32 v253, s76, v253
    global_load_dwordx2 v[254:255], v253, s[38:39]
    s_waitcnt lgkmcnt(0)
    s_add_u32 s46, s46, 1
    s_addc_u32 s47, s47, 0
    s_barrier
    ds_read_b128 v[192:195], v212 offset:0
    ds_read_b128 v[196:199], v212 offset:256
    ds_read_b128 v[128:131], v208 offset:0
    ds_read_b128 v[132:135], v208 offset:2048
    ds_read_b128 v[136:139], v208 offset:4096
    ds_read_b128 v[140:143], v208 offset:6144
    ds_read_b128 v[144:147], v208 offset:8192
    ds_read_b128 v[148:151], v208 offset:10240
    ds_read_b128 v[152:155], v208 offset:12288
    ds_read_b128 v[156:159], v208 offset:14336
    s_cmp_lg_u32 s10, 0
    s_cbranch_scc1 L_B_noxcc
    s_getreg_b32 s76, hwreg(HW_REG_XCC_ID)
    s_and_b32 s76, s76, 15
    v_mov_b32 v240, s76
    v_mov_b32 v241, 1
    v_mov_b32 v242, s46
    v_mov_b32 v243, s47
    v_mov_b32 v244, 0
    s_lshl_b32 s77, s8, 4
    s_add_u32 s77, s77, s6
    s_lshl_b32 s77, s77, 3
    s_add_u32 s77, s77, s7
    s_lshl_b32 s77, s77, 7
    s_add_u32 s77, s77, 0x8000
    s_mov_b64 exec, 1
    buffer_store_dwordx4 v[240:243], v244, s[68:71], s77 offen sc1
    s_mov_b64 exec, -1
L_B_noxcc:
    s_waitcnt lgkmcnt(0)
    v_mfma_f32_16x16x32_bf16 v[64:67], v[192:195], v[128:131], 0
    ds_read_b128 v[200:203], v213 offset:0
    v_mfma_f32_16x16x32_bf16 v[96:99], v[196:199], v[128:131], 0
    ds_read_b128 v[204:207], v213 offset:256
    v_mfma_f32_16x16x32_bf16 v[68:71], v[192:195], v[132:135], 0
    ds_read_b128 v[160:163], v209 offset:0
    v_mfma_f32_16x16x32_bf16 v[100:103], v[196:199], v[132:135], 0
    ds_read_b128 v[164:167], v209 offset:2048
    v_mfma_f32_16x16x32_bf16 v[72:75], v[192:195], v[136:139], 0
    ds_read_b128 v[168:171], v209 offset:4096
    v_mfma_f32_16x16x32_bf16 v[104:107], v[196:199], v[136:139], 0
    ds_read_b128 v[172:175], v209 offset:6144
    v_mfma_f32_16x16x32_bf16 v[76:79], v[192:195], v[140:143], 0
    ds_read_b128 v[176:179], v209 offset:8192
    v_mfma_f32_16x16x32_bf16 v[108:111], v[196:199], v[140:143], 0
    ds_read_b128 v[180:183], v209 offset:10240
    v_mfma_f32_16x16x32_bf16 v[80:83], v[192:195], v[144:147], 0
    ds_read_b128 v[184:187], v209 offset:12288
    v_mfma_f32_16x16x32_bf16 v[112:115], v[196:199], v[144:147], 0
    ds_read_b128 v[188:191], v209 offset:14336
    v_mfma_f32_16x16x32_bf16 v[84:87], v[192:195], v[148:151], 0
    v_mfma_f32_16x16x32_bf16 v[116:119], v[196:199], v[148:151], 0
    v_mfma_f32_16x16x32_bf16 v[88:91], v[192:195], v[152:155], 0
    v_mfma_f32_16x16x32_bf16 v[120:123], v[196:199], v[152:155], 0
    v_mfma_f32_16x16x32_bf16 v[92:95], v[192:195], v[156:159], 0
    v_mfma_f32_16x16x32_bf16 v[124:127], v[196:199], v[156:159], 0
    s_waitcnt lgkmcnt(0)
    s_barrier
    v_mfma_f32_16x16x32_bf16 v[64:67], v[200:203], v[160:163], v[64:67]
    ds_read_b128 v[192:195], v212 offset:32768
    v_mfma_f32_16x16x32_bf16 v[96:99], v[204:207], v[160:163], v[96:99]
    ds_read_b128 v[196:199], v212 offset:33024
    v_mfma_f32_16x16x32_bf16 v[68:71], v[200:203], v[164:167], v[68:71]
    ds_read_b128 v[128:131], v208 offset:32768
    v_mfma_f32_16x16x32_bf16 v[100:103], v[204:207], v[164:167], v[100:103]
    ds_read_b128 v[132:135], v208 offset:34816
    v_mfma_f32_16x16x32_bf16 v[72:75], v[200:203], v[168:171], v[72:75]
    ds_read_b128 v[136:139], v208 offset:36864
    v_mfma_f32_16x16x32_bf16 v[104:107], v[204:207], v[168:171], v[104:107]
    ds_read_b128 v[140:143], v208 offset:38912
    v_mfma_f32_16x16x32_bf16 v[76:79], v[200:203], v[172:175], v[76:79]
    ds_read_b128 v[144:147], v208 offset:40960
    v_mfma_f32_16x16x32_bf16 v[108:111], v[204:207], v[172:175], v[108:111]
    ds_read_b128 v[148:151], v208 offset:43008
    v_mfma_f32_16x16x32_bf16 v[80:83], v[200:203], v[176:179], v[80:83]
    ds_read_b128 v[152:155], v208 offset:45056
    v_mfma_f32_16x16x32_bf16 v[112:115], v[204:207], v[176:179], v[112:115]
    ds_read_b128 v[156:159], v208 offset:47104
    v_mfma_f32_16x16x32_bf16 v[84:87], v[200:203], v[180:183], v[84:87]
    v_mfma_f32_16x16x32_bf16 v[116:119], v[204:207], v[180:183], v[116:119]
    v_mfma_f32_16x16x32_bf16 v[88:91], v[200:203], v[184:187], v[88:91]
    v_mfma_f32_16x16x32_bf16 v[120:123], v[204:207], v[184:187], v[120:123]
    v_mfma_f32_16x16x32_bf16 v[92:95], v[200:203], v[188:191], v[92:95]
    v_mfma_f32_16x16x32_bf16 v[124:127], v[204:207], v[188:191], v[124:127]
    s_waitcnt lgkmcnt(0)
    v_mfma_f32_16x16x32_bf16 v[64:67], v[192:195], v[128:131], v[64:67]
    ds_read_b128 v[200:203], v213 offset:32768
    v_mfma_f32_16x16x32_bf16 v[96:99], v[196:199], v[128:131], v[96:99]
    ds_read_b128 v[204:207], v213 offset:33024
    v_mfma_f32_16x16x32_bf16 v[68:71], v[192:195], v[132:135], v[68:71]
    ds_read_b128 v[160:163], v209 offset:32768
    v_mfma_f32_16x16x32_bf16 v[100:103], v[196:199], v[132:135], v[100:103]
    ds_read_b128 v[164:167], v209 offset:34816
    v_mfma_f32_16x16x32_bf16 v[72:75], v[192:195], v[136:139], v[72:75]
    ds_read_b128 v[168:171], v209 offset:36864
    v_mfma_f32_16x16x32_bf16 v[104:107], v[196:199], v[136:139], v[104:107]
    ds_read_b128 v[172:175], v209 offset:38912
    v_mfma_f32_16x16x32_bf16 v[76:79], v[192:195], v[140:143], v[76:79]
    ds_read_b128 v[176:179], v209 offset:40960
    v_mfma_f32_16x16x32_bf16 v[108:111], v[196:199], v[140:143], v[108:111]
    ds_read_b128 v[180:183], v209 offset:43008
    v_mfma_f32_16x16x32_bf16 v[80:83], v[192:195], v[144:147], v[80:83]
    ds_read_b128 v[184:187], v209 offset:45056
    v_mfma_f32_16x16x32_bf16 v[112:115], v[196:199], v[144:147], v[112:115]
    ds_read_b128 v[188:191], v209 offset:47104
    v_mfma_f32_16x16x32_bf16 v[84:87], v[192:195], v[148:151], v[84:87]
    v_mfma_f32_16x16x32_bf16 v[116:119], v[196:199], v[148:151], v[116:119]
    v_mfma_f32_16x16x32_bf16 v[88:91], v[192:195], v[152:155], v[88:91]
    v_mfma_f32_16x16x32_bf16 v[120:123], v[196:199], v[152:155], v[120:123]
    v_mfma_f32_16x16x32_bf16 v[92:95], v[192:195], v[156:159], v[92:95]
    v_mfma_f32_16x16x32_bf16 v[124:127], v[196:199], v[156:159], v[124:127]
    s_waitcnt lgkmcnt(0)
    s_barrier
    v_mfma_f32_16x16x32_bf16 v[64:67], v[200:203], v[160:163], v[64:67]
    ds_read_b128 v[192:195], v214 offset:0
    v_mfma_f32_16x16x32_bf16 v[96:99], v[204:207], v[160:163], v[96:99]
    ds_read_b128 v[196:199], v214 offset:256
    v_mfma_f32_16x16x32_bf16 v[68:71], v[200:203], v[164:167], v[68:71]
    ds_read_b128 v[128:131], v210 offset:0
    v_mfma_f32_16x16x32_bf16 v[100:103], v[204:207], v[164:167], v[100:103]
    ds_read_b128 v[132:135], v210 offset:2048
    v_mfma_f32_16x16x32_bf16 v[72:75], v[200:203], v[168:171], v[72:75]
    ds_read_b128 v[136:139], v210 offset:4096
    v_mfma_f32_16x16x32_bf16 v[104:107], v[204:207], v[168:171], v[104:107]
    ds_read_b128 v[140:143], v210 offset:6144
    v_mfma_f32_16x16x32_bf16 v[76:79], v[200:203], v[172:175], v[76:79]
    ds_read_b128 v[144:147], v210 offset:8192
    v_mfma_f32_16x16x32_bf16 v[108:111], v[204:207], v[172:175], v[108:111]
    ds_read_b128 v[148:151], v210 offset:10240
    v_mfma_f32_16x16x32_bf16 v[80:83], v[200:203], v[176:179], v[80:83]
    ds_read_b128 v[152:155], v210 offset:12288
    v_mfma_f32_16x16x32_bf16 v[112:115], v[204:207], v[176:179], v[112:115]
    ds_read_b128 v[156:159], v210 offset:14336
    v_mfma_f32_16x16x32_bf16 v[84:87], v[200:203], v[180:183], v[84:87]
    v_mfma_f32_16x16x32_bf16 v[116:119], v[204:207], v[180:183], v[116:119]
    v_mfma_f32_16x16x32_bf16 v[88:91], v[200:203], v[184:187], v[88:91]
    v_mfma_f32_16x16x32_bf16 v[120:123], v[204:207], v[184:187], v[120:123]
    v_mfma_f32_16x16x32_bf16 v[92:95], v[200:203], v[188:191], v[92:95]
    v_mfma_f32_16x16x32_bf16 v[124:127], v[204:207], v[188:191], v[124:127]
    s_waitcnt lgkmcnt(0)
    v_mfma_f32_16x16x32_bf16 v[64:67], v[192:195], v[128:131], v[64:67]
    ds_read_b128 v[200:203], v215 offset:0
    v_mfma_f32_16x16x32_bf16 v[96:99], v[196:199], v[128:131], v[96:99]
    ds_read_b128 v[204:207], v215 offset:256
    v_mfma_f32_16x16x32_bf16 v[68:71], v[192:195], v[132:135], v[68:71]
    ds_read_b128 v[160:163], v211 offset:0
    v_mfma_f32_16x16x32_bf16 v[100:103], v[196:199], v[132:135], v[100:103]
    ds_read_b128 v[164:167], v211 offset:2048
    v_mfma_f32_16x16x32_bf16 v[72:75], v[192:195], v[136:139], v[72:75]
    ds_read_b128 v[168:171], v211 offset:4096
    v_mfma_f32_16x16x32_bf16 v[104:107], v[196:199], v[136:139], v[104:107]
    ds_read_b128 v[172:175], v211 offset:6144
    v_mfma_f32_16x16x32_bf16 v[76:79], v[192:195], v[140:143], v[76:79]
    ds_read_b128 v[176:179], v211 offset:8192
    v_mfma_f32_16x16x32_bf16 v[108:111], v[196:199], v[140:143], v[108:111]
    ds_read_b128 v[180:183], v211 offset:10240
    v_mfma_f32_16x16x32_bf16 v[80:83], v[192:195], v[144:147], v[80:83]
    ds_read_b128 v[184:187], v211 offset:12288
    v_mfma_f32_16x16x32_bf16 v[112:115], v[196:199], v[144:147], v[112:115]
    ds_read_b128 v[188:191], v211 offset:14336
    v_mfma_f32_16x16x32_bf16 v[84:87], v[192:195], v[148:151], v[84:87]
    v_mfma_f32_16x16x32_bf16 v[116:119], v[196:199], v[148:151], v[116:119]
    v_mfma_f32_16x16x32_bf16 v[88:91], v[192:195], v[152:155], v[88:91]
    v_mfma_f32_16x16x32_bf16 v[120:123], v[196:199], v[152:155], v[120:123]
    v_mfma_f32_16x16x32_bf16 v[92:95], v[192:195], v[156:159], v[92:95]
    v_mfma_f32_16x16x32_bf16 v[124:127], v[196:199], v[156:159], v[124:127]
    s_waitcnt lgkmcnt(0)
    s_barrier
    v_mfma_f32_16x16x32_bf16 v[64:67], v[200:203], v[160:163], v[64:67]
    ds_read_b128 v[192:195], v214 offset:32768
    v_mfma_f32_16x16x32_bf16 v[96:99], v[204:207], v[160:163], v[96:99]
    ds_read_b128 v[196:199], v214 offset:33024
    v_mfma_f32_16x16x32_bf16 v[68:71], v[200:203], v[164:167], v[68:71]
    ds_read_b128 v[128:131], v210 offset:32768
    v_mfma_f32_16x16x32_bf16 v[100:103], v[204:207], v[164:167], v[100:103]
    ds_read_b128 v[132:135], v210 offset:34816
    v_mfma_f32_16x16x32_bf16 v[72:75], v[200:203], v[168:171], v[72:75]
    ds_read_b128 v[136:139], v210 offset:36864
    v_mfma_f32_16x16x32_bf16 v[104:107], v[204:207], v[168:171], v[104:107]
    ds_read_b128 v[140:143], v210 offset:38912
    v_mfma_f32_16x16x32_bf16 v[76:79], v[200:203], v[172:175], v[76:79]
    ds_read_b128 v[144:147], v210 offset:40960
    v_mfma_f32_16x16x32_bf16 v[108:111], v[204:207], v[172:175], v[108:111]
    ds_read_b128 v[148:151], v210 offset:43008
    v_mfma_f32_16x16x32_bf16 v[80:83], v[200:203], v[176:179], v[80:83]
    ds_read_b128 v[152:155], v210 offset:45056
    v_mfma_f32_16x16x32_bf16 v[112:115], v[204:207], v[176:179], v[112:115]
    ds_read_b128 v[156:159], v210 offset:47104
    v_mfma_f32_16x16x32_bf16 v[84:87], v[200:203], v[180:183], v[84:87]
    v_mfma_f32_16x16x32_bf16 v[116:119], v[204:207], v[180:183], v[116:119]
    v_mfma_f32_16x16x32_bf16 v[88:91], v[200:203], v[184:187], v[88:91]
    v_mfma_f32_16x16x32_bf16 v[120:123], v[204:207], v[184:187], v[120:123]
    v_mfma_f32_16x16x32_bf16 v[92:95], v[200:203], v[188:191], v[92:95]
    v_mfma_f32_16x16x32_bf16 v[124:127], v[204:207], v[188:191], v[124:127]
    s_waitcnt lgkmcnt(0)
    v_mfma_f32_16x16x32_bf16 v[64:67], v[192:195], v[128:131], v[64:67]
    ds_read_b128 v[200:203], v215 offset:32768
    v_mfma_f32_16x16x32_bf16 v[96:99], v[196:199], v[128:131], v[96:99]
    ds_read_b128 v[204:207], v215 offset:33024
    v_mfma_f32_16x16x32_bf16 v[68:71], v[192:195], v[132:135], v[68:71]
    ds_read_b128 v[160:163], v211 offset:32768
    v_mfma_f32_16x16x32_bf16 v[100:103], v[196:199], v[132:135], v[100:103]
    ds_read_b128 v[164:167], v211 offset:34816
    v_mfma_f32_16x16x32_bf16 v[72:75], v[192:195], v[136:139], v[72:75]
    ds_read_b128 v[168:171], v211 offset:36864
    v_mfma_f32_16x16x32_bf16 v[104:107], v[196:199], v[136:139], v[104:107]
    ds_read_b128 v[172:175], v211 offset:38912
    v_mfma_f32_16x16x32_bf16 v[76:79], v[192:195], v[140:143], v[76:79]
    ds_read_b128 v[176:179], v211 offset:40960
    v_mfma_f32_16x16x32_bf16 v[108:111], v[196:199], v[140:143], v[108:111]
    ds_read_b128 v[180:183], v211 offset:43008
    v_mfma_f32_16x16x32_bf16 v[80:83], v[192:195], v[144:147], v[80:83]
    ds_read_b128 v[184:187], v211 offset:45056
    v_mfma_f32_16x16x32_bf16 v[112:115], v[196:199], v[144:147], v[112:115]
    ds_read_b128 v[188:191], v211 offset:47104
    v_mfma_f32_16x16x32_bf16 v[84:87], v[192:195], v[148:151], v[84:87]
    v_mfma_f32_16x16x32_bf16 v[116:119], v[196:199], v[148:151], v[116:119]
    v_mfma_f32_16x16x32_bf16 v[88:91], v[192:195], v[152:155], v[88:91]
    v_mfma_f32_16x16x32_bf16 v[120:123], v[196:199], v[152:155], v[120:123]
    v_mfma_f32_16x16x32_bf16 v[92:95], v[192:195], v[156:159], v[92:95]
    v_mfma_f32_16x16x32_bf16 v[124:127], v[196:199], v[156:159], v[124:127]
    s_waitcnt lgkmcnt(0)
    s_barrier
    v_mfma_f32_16x16x32_bf16 v[64:67], v[200:203], v[160:163], v[64:67]
    ds_read_b128 v[192:195], v212 offset:0
    v_mfma_f32_16x16x32_bf16 v[96:99], v[204:207], v[160:163], v[96:99]
    ds_read_b128 v[196:199], v212 offset:256
    v_mfma_f32_16x16x32_bf16 v[68:71], v[200:203], v[164:167], v[68:71]
    ds_read_b128 v[128:131], v208 offset:0
    v_mfma_f32_16x16x32_bf16 v[100:103], v[204:207], v[164:167], v[100:103]
    ds_read_b128 v[132:135], v208 offset:2048
    v_mfma_f32_16x16x32_bf16 v[72:75], v[200:203], v[168:171], v[72:75]
    ds_read_b128 v[136:139], v208 offset:4096
    v_mfma_f32_16x16x32_bf16 v[104:107], v[204:207], v[168:171], v[104:107]
    ds_read_b128 v[140:143], v208 offset:6144
    v_mfma_f32_16x16x32_bf16 v[76:79], v[200:203], v[172:175], v[76:79]
    ds_read_b128 v[144:147], v208 offset:8192
    v_mfma_f32_16x16x32_bf16 v[108:111], v[204:207], v[172:175], v[108:111]
    ds_read_b128 v[148:151], v208 offset:10240
    v_mfma_f32_16x16x32_bf16 v[80:83], v[200:203], v[176:179], v[80:83]
    ds_read_b128 v[152:155], v208 offset:12288
    v_mfma_f32_16x16x32_bf16 v[112:115], v[204:207], v[176:179], v[112:115]
    ds_read_b128 v[156:159], v208 offset:14336
    v_mfma_f32_16x16x32_bf16 v[84:87], v[200:203], v[180:183], v[84:87]
    v_mfma_f32_16x16x32_bf16 v[116:119], v[204:207], v[180:183], v[116:119]
    v_mfma_f32_16x16x32_bf16 v[88:91], v[200:203], v[184:187], v[88:91]
    v_mfma_f32_16x16x32_bf16 v[120:123], v[204:207], v[184:187], v[120:123]
    v_mfma_f32_16x16x32_bf16 v[92:95], v[200:203], v[188:191], v[92:95]
    v_mfma_f32_16x16x32_bf16 v[124:127], v[204:207], v[188:191], v[124:127]
    s_waitcnt lgkmcnt(0)
    v_mfma_f32_16x16x32_bf16 v[64:67], v[192:195], v[128:131], v[64:67]
    ds_read_b128 v[200:203], v213 offset:0
    v_mfma_f32_16x16x32_bf16 v[96:99], v[196:199], v[128:131], v[96:99]
    ds_read_b128 v[204:207], v213 offset:256
    v_mfma_f32_16x16x32_bf16 v[68:71], v[192:195], v[132:135], v[68:71]
    ds_read_b128 v[160:163], v209 offset:0
    v_mfma_f32_16x16x32_bf16 v[100:103], v[196:199], v[132:135], v[100:103]
    ds_read_b128 v[164:167], v209 offset:2048
    v_mfma_f32_16x16x32_bf16 v[72:75], v[192:195], v[136:139], v[72:75]
    ds_read_b128 v[168:171], v209 offset:4096
    v_mfma_f32_16x16x32_bf16 v[104:107], v[196:199], v[136:139], v[104:107]
    ds_read_b128 v[172:175], v209 offset:6144
    v_mfma_f32_16x16x32_bf16 v[76:79], v[192:195], v[140:143], v[76:79]
    ds_read_b128 v[176:179], v209 offset:8192
    v_mfma_f32_16x16x32_bf16 v[108:111], v[196:199], v[140:143], v[108:111]
    ds_read_b128 v[180:183], v209 offset:10240
    v_mfma_f32_16x16x32_bf16 v[80:83], v[192:195], v[144:147], v[80:83]
    ds_read_b128 v[184:187], v209 offset:12288
    v_mfma_f32_16x16x32_bf16 v[112:115], v[196:199], v[144:147], v[112:115]
    ds_read_b128 v[188:191], v209 offset:14336
    v_mfma_f32_16x16x32_bf16 v[84:87], v[192:195], v[148:151], v[84:87]
    v_mfma_f32_16x16x32_bf16 v[116:119], v[196:199], v[148:151], v[116:119]
    v_mfma_f32_16x16x32_bf16 v[88:91], v[192:195], v[152:155], v[88:91]
    v_mfma_f32_16x16x32_bf16 v[120:123], v[196:199], v[152:155], v[120:123]
    v_mfma_f32_16x16x32_bf16 v[92:95], v[192:195], v[156:159], v[92:95]
    v_mfma_f32_16x16x32_bf16 v[124:127], v[196:199], v[156:159], v[124:127]
    s_waitcnt lgkmcnt(0)
    s_barrier
    v_mfma_f32_16x16x32_bf16 v[64:67], v[200:203], v[160:163], v[64:67]
    ds_read_b128 v[192:195], v212 offset:32768
    v_mfma_f32_16x16x32_bf16 v[96:99], v[204:207], v[160:163], v[96:99]
    ds_read_b128 v[196:199], v212 offset:33024
    v_mfma_f32_16x16x32_bf16 v[68:71], v[200:203], v[164:167], v[68:71]
    ds_read_b128 v[128:131], v208 offset:32768
    v_mfma_f32_16x16x32_bf16 v[100:103], v[204:207], v[164:167], v[100:103]
    ds_read_b128 v[132:135], v208 offset:34816
    v_mfma_f32_16x16x32_bf16 v[72:75], v[200:203], v[168:171], v[72:75]
    ds_read_b128 v[136:139], v208 offset:36864
    v_mfma_f32_16x16x32_bf16 v[104:107], v[204:207], v[168:171], v[104:107]
    ds_read_b128 v[140:143], v208 offset:38912
    v_mfma_f32_16x16x32_bf16 v[76:79], v[200:203], v[172:175], v[76:79]
    ds_read_b128 v[144:147], v208 offset:40960
    v_mfma_f32_16x16x32_bf16 v[108:111], v[204:207], v[172:175], v[108:111]
    ds_read_b128 v[148:151], v208 offset:43008
    v_mfma_f32_16x16x32_bf16 v[80:83], v[200:203], v[176:179], v[80:83]
    ds_read_b128 v[152:155], v208 offset:45056
    v_mfma_f32_16x16x32_bf16 v[112:115], v[204:207], v[176:179], v[112:115]
    ds_read_b128 v[156:159], v208 offset:47104
    v_mfma_f32_16x16x32_bf16 v[84:87], v[200:203], v[180:183], v[84:87]
    v_mfma_f32_16x16x32_bf16 v[116:119], v[204:207], v[180:183], v[116:119]
    v_mfma_f32_16x16x32_bf16 v[88:91], v[200:203], v[184:187], v[88:91]
    v_mfma_f32_16x16x32_bf16 v[120:123], v[204:207], v[184:187], v[120:123]
    v_mfma_f32_16x16x32_bf16 v[92:95], v[200:203], v[188:191], v[92:95]
    v_mfma_f32_16x16x32_bf16 v[124:127], v[204:207], v[188:191], v[124:127]
    s_waitcnt lgkmcnt(0)
    v_mfma_f32_16x16x32_bf16 v[64:67], v[192:195], v[128:131], v[64:67]
    ds_read_b128 v[200:203], v213 offset:32768
    v_mfma_f32_16x16x32_bf16 v[96:99], v[196:199], v[128:131], v[96:99]
    ds_read_b128 v[204:207], v213 offset:33024
    v_mfma_f32_16x16x32_bf16 v[68:71], v[192:195], v[132:135], v[68:71]
    ds_read_b128 v[160:163], v209 offset:32768
    v_mfma_f32_16x16x32_bf16 v[100:103], v[196:199], v[132:135], v[100:103]
    ds_read_b128 v[164:167], v209 offset:34816
    v_mfma_f32_16x16x32_bf16 v[72:75], v[192:195], v[136:139], v[72:75]
    ds_read_b128 v[168:171], v209 offset:36864
    v_mfma_f32_16x16x32_bf16 v[104:107], v[196:199], v[136:139], v[104:107]
    ds_read_b128 v[172:175], v209 offset:38912
    v_mfma_f32_16x16x32_bf16 v[76:79], v[192:195], v[140:143], v[76:79]
    ds_read_b128 v[176:179], v209 offset:40960
    v_mfma_f32_16x16x32_bf16 v[108:111], v[196:199], v[140:143], v[108:111]
    ds_read_b128 v[180:183], v209 offset:43008
    v_mfma_f32_16x16x32_bf16 v[80:83], v[192:195], v[144:147], v[80:83]
    ds_read_b128 v[184:187], v209 offset:45056
    v_mfma_f32_16x16x32_bf16 v[112:115], v[196:199], v[144:147], v[112:115]
    ds_read_b128 v[188:191], v209 offset:47104
    v_mfma_f32_16x16x32_bf16 v[84:87], v[192:195], v[148:151], v[84:87]
    v_mfma_f32_16x16x32_bf16 v[116:119], v[196:199], v[148:151], v[116:119]
    v_mfma_f32_16x16x32_bf16 v[88:91], v[192:195], v[152:155], v[88:91]
    v_mfma_f32_16x16x32_bf16 v[120:123], v[196:199], v[152:155], v[120:123]
    v_mfma_f32_16x16x32_bf16 v[92:95], v[192:195], v[156:159], v[92:95]
    v_mfma_f32_16x16x32_bf16 v[124:127], v[196:199], v[156:159], v[124:127]
    s_waitcnt lgkmcnt(0)
    s_barrier
    v_mfma_f32_16x16x32_bf16 v[64:67], v[200:203], v[160:163], v[64:67]
    ds_read_b128 v[192:195], v214 offset:0
    v_mfma_f32_16x16x32_bf16 v[96:99], v[204:207], v[160:163], v[96:99]
    ds_read_b128 v[196:199], v214 offset:256
    v_mfma_f32_16x16x32_bf16 v[68:71], v[200:203], v[164:167], v[68:71]
    ds_read_b128 v[128:131], v210 offset:0
    v_mfma_f32_16x16x32_bf16 v[100:103], v[204:207], v[164:167], v[100:103]
    ds_read_b128 v[132:135], v210 offset:2048
    v_mfma_f32_16x16x32_bf16 v[72:75], v[200:203], v[168:171], v[72:75]
    ds_read_b128 v[136:139], v210 offset:4096
    v_mfma_f32_16x16x32_bf16 v[104:107], v[204:207], v[168:171], v[104:107]
    ds_read_b128 v[140:143], v210 offset:6144
    v_mfma_f32_16x16x32_bf16 v[76:79], v[200:203], v[172:175], v[76:79]
    ds_read_b128 v[144:147], v210 offset:8192
    v_mfma_f32_16x16x32_bf16 v[108:111], v[204:207], v[172:175], v[108:111]
    ds_read_b128 v[148:151], v210 offset:10240
    v_mfma_f32_16x16x32_bf16 v[80:83], v[200:203], v[176:179], v[80:83]
    ds_read_b128 v[152:155], v210 offset:12288
    v_mfma_f32_16x16x32_bf16 v[112:115], v[204:207], v[176:179], v[112:115]
    ds_read_b128 v[156:159], v210 offset:14336
    v_mfma_f32_16x16x32_bf16 v[84:87], v[200:203], v[180:183], v[84:87]
    v_mfma_f32_16x16x32_bf16 v[116:119], v[204:207], v[180:183], v[116:119]
    v_mfma_f32_16x16x32_bf16 v[88:91], v[200:203], v[184:187], v[88:91]
    v_mfma_f32_16x16x32_bf16 v[120:123], v[204:207], v[184:187], v[120:123]
    v_mfma_f32_16x16x32_bf16 v[92:95], v[200:203], v[188:191], v[92:95]
    v_mfma_f32_16x16x32_bf16 v[124:127], v[204:207], v[188:191], v[124:127]
    s_waitcnt lgkmcnt(0)
    v_mfma_f32_16x16x32_bf16 v[64:67], v[192:195], v[128:131], v[64:67]
    ds_read_b128 v[200:203], v215 offset:0
    v_mfma_f32_16x16x32_bf16 v[96:99], v[196:199], v[128:131], v[96:99]
    ds_read_b128 v[204:207], v215 offset:256
    v_mfma_f32_16x16x32_bf16 v[68:71], v[192:195], v[132:135], v[68:71]
    ds_read_b128 v[160:163], v211 offset:0
    v_mfma_f32_16x16x32_bf16 v[100:103], v[196:199], v[132:135], v[100:103]
    ds_read_b128 v[164:167], v211 offset:2048
    v_mfma_f32_16x16x32_bf16 v[72:75], v[192:195], v[136:139], v[72:75]
    ds_read_b128 v[168:171], v211 offset:4096
    v_mfma_f32_16x16x32_bf16 v[104:107], v[196:199], v[136:139], v[104:107]
    ds_read_b128 v[172:175], v211 offset:6144
    v_mfma_f32_16x16x32_bf16 v[76:79], v[192:195], v[140:143], v[76:79]
    ds_read_b128 v[176:179], v211 offset:8192
    v_mfma_f32_16x16x32_bf16 v[108:111], v[196:199], v[140:143], v[108:111]
    ds_read_b128 v[180:183], v211 offset:10240
    v_mfma_f32_16x16x32_bf16 v[80:83], v[192:195], v[144:147], v[80:83]
    ds_read_b128 v[184:187], v211 offset:12288
    v_mfma_f32_16x16x32_bf16 v[112:115], v[196:199], v[144:147], v[112:115]
    ds_read_b128 v[188:191], v211 offset:14336
    v_mfma_f32_16x16x32_bf16 v[84:87], v[192:195], v[148:151], v[84:87]
    v_mfma_f32_16x16x32_bf16 v[116:119], v[196:199], v[148:151], v[116:119]
    v_mfma_f32_16x16x32_bf16 v[88:91], v[192:195], v[152:155], v[88:91]
    v_mfma_f32_16x16x32_bf16 v[120:123], v[196:199], v[152:155], v[120:123]
    v_mfma_f32_16x16x32_bf16 v[92:95], v[192:195], v[156:159], v[92:95]
    v_mfma_f32_16x16x32_bf16 v[124:127], v[196:199], v[156:159], v[124:127]
    s_waitcnt lgkmcnt(0)
    s_barrier
    v_mfma_f32_16x16x32_bf16 v[64:67], v[200:203], v[160:163], v[64:67]
    ds_read_b128 v[192:195], v214 offset:32768
    v_mfma_f32_16x16x32_bf16 v[96:99], v[204:207], v[160:163], v[96:99]
    ds_read_b128 v[196:199], v214 offset:33024
    v_mfma_f32_16x16x32_bf16 v[68:71], v[200:203], v[164:167], v[68:71]
    ds_read_b128 v[128:131], v210 offset:32768
    v_mfma_f32_16x16x32_bf16 v[100:103], v[204:207], v[164:167], v[100:103]
    ds_read_b128 v[132:135], v210 offset:34816
    v_mfma_f32_16x16x32_bf16 v[72:75], v[200:203], v[168:171], v[72:75]
    ds_read_b128 v[136:139], v210 offset:36864
    v_mfma_f32_16x16x32_bf16 v[104:107], v[204:207], v[168:171], v[104:107]
    ds_read_b128 v[140:143], v210 offset:38912
    v_mfma_f32_16x16x32_bf16 v[76:79], v[200:203], v[172:175], v[76:79]
    ds_read_b128 v[144:147], v210 offset:40960
    v_mfma_f32_16x16x32_bf16 v[108:111], v[204:207], v[172:175], v[108:111]
    ds_read_b128 v[148:151], v210 offset:43008
    v_mfma_f32_16x16x32_bf16 v[80:83], v[200:203], v[176:179], v[80:83]
    ds_read_b128 v[152:155], v210 offset:45056
    v_mfma_f32_16x16x32_bf16 v[112:115], v[204:207], v[176:179], v[112:115]
    ds_read_b128 v[156:159], v210 offset:47104
    v_mfma_f32_16x16x32_bf16 v[84:87], v[200:203], v[180:183], v[84:87]
    v_mfma_f32_16x16x32_bf16 v[116:119], v[204:207], v[180:183], v[116:119]
    v_mfma_f32_16x16x32_bf16 v[88:91], v[200:203], v[184:187], v[88:91]
    v_mfma_f32_16x16x32_bf16 v[120:123], v[204:207], v[184:187], v[120:123]
    v_mfma_f32_16x16x32_bf16 v[92:95], v[200:203], v[188:191], v[92:95]
    v_mfma_f32_16x16x32_bf16 v[124:127], v[204:207], v[188:191], v[124:127]
    s_waitcnt lgkmcnt(0)
    v_mfma_f32_16x16x32_bf16 v[64:67], v[192:195], v[128:131], v[64:67]
    ds_read_b128 v[200:203], v215 offset:32768
    v_mfma_f32_16x16x32_bf16 v[96:99], v[196:199], v[128:131], v[96:99]
    ds_read_b128 v[204:207], v215 offset:33024
    v_mfma_f32_16x16x32_bf16 v[68:71], v[192:195], v[132:135], v[68:71]
    ds_read_b128 v[160:163], v211 offset:32768
    v_mfma_f32_16x16x32_bf16 v[100:103], v[196:199], v[132:135], v[100:103]
    ds_read_b128 v[164:167], v211 offset:34816
    v_mfma_f32_16x16x32_bf16 v[72:75], v[192:195], v[136:139], v[72:75]
    ds_read_b128 v[168:171], v211 offset:36864
    v_mfma_f32_16x16x32_bf16 v[104:107], v[196:199], v[136:139], v[104:107]
    ds_read_b128 v[172:175], v211 offset:38912
    v_mfma_f32_16x16x32_bf16 v[76:79], v[192:195], v[140:143], v[76:79]
    ds_read_b128 v[176:179], v211 offset:40960
    v_mfma_f32_16x16x32_bf16 v[108:111], v[196:199], v[140:143], v[108:111]
    ds_read_b128 v[180:183], v211 offset:43008
    v_mfma_f32_16x16x32_bf16 v[80:83], v[192:195], v[144:147], v[80:83]
    ds_read_b128 v[184:187], v211 offset:45056
    v_mfma_f32_16x16x32_bf16 v[112:115], v[196:199], v[144:147], v[112:115]
    ds_read_b128 v[188:191], v211 offset:47104
    v_mfma_f32_16x16x32_bf16 v[84:87], v[192:195], v[148:151], v[84:87]
    v_mfma_f32_16x16x32_bf16 v[116:119], v[196:199], v[148:151], v[116:119]
    v_mfma_f32_16x16x32_bf16 v[88:91], v[192:195], v[152:155], v[88:91]
    v_mfma_f32_16x16x32_bf16 v[120:123], v[196:199], v[152:155], v[120:123]
    v_mfma_f32_16x16x32_bf16 v[92:95], v[192:195], v[156:159], v[92:95]
    v_mfma_f32_16x16x32_bf16 v[124:127], v[196:199], v[156:159], v[124:127]
    s_waitcnt lgkmcnt(0)
    s_barrier
    v_mfma_f32_16x16x32_bf16 v[64:67], v[200:203], v[160:163], v[64:67]
    v_mfma_f32_16x16x32_bf16 v[96:99], v[204:207], v[160:163], v[96:99]
    v_mfma_f32_16x16x32_bf16 v[68:71], v[200:203], v[164:167], v[68:71]
    v_mfma_f32_16x16x32_bf16 v[100:103], v[204:207], v[164:167], v[100:103]
    v_mfma_f32_16x16x32_bf16 v[72:75], v[200:203], v[168:171], v[72:75]
    v_mfma_f32_16x16x32_bf16 v[104:107], v[204:207], v[168:171], v[104:107]
    v_mfma_f32_16x16x32_bf16 v[76:79], v[200:203], v[172:175], v[76:79]
    v_mfma_f32_16x16x32_bf16 v[108:111], v[204:207], v[172:175], v[108:111]
    v_mfma_f32_16x16x32_bf16 v[80:83], v[200:203], v[176:179], v[80:83]
    v_mfma_f32_16x16x32_bf16 v[112:115], v[204:207], v[176:179], v[112:115]
    v_mfma_f32_16x16x32_bf16 v[84:87], v[200:203], v[180:183], v[84:87]
    v_mfma_f32_16x16x32_bf16 v[116:119], v[204:207], v[180:183], v[116:119]
    v_mfma_f32_16x16x32_bf16 v[88:91], v[200:203], v[184:187], v[88:91]
    v_mfma_f32_16x16x32_bf16 v[120:123], v[204:207], v[184:187], v[120:123]
    v_mfma_f32_16x16x32_bf16 v[92:95], v[200:203], v[188:191], v[92:95]
    v_mfma_f32_16x16x32_bf16 v[124:127], v[204:207], v[188:191], v[124:127]
    v_mov_b32 v130, s46
    v_mov_b32 v131, s47
    v_mov_b32 v134, s46
    v_mov_b32 v135, s47
    v_mov_b32 v138, s46
    v_mov_b32 v139, s47
    v_mov_b32 v142, s46
    v_mov_b32 v143, s47
    v_pk_fma_f32 v[144:145], v[64:65], v[8:9], v[68:69] op_sel_hi:[1,0,1]
    v_pk_fma_f32 v[146:147], v[66:67], v[10:11], v[70:71] op_sel_hi:[1,0,1]
    v_pk_fma_f32 v[148:149], v[96:97], v[12:13], v[100:101] op_sel_hi:[1,0,1]
    v_pk_fma_f32 v[150:151], v[98:99], v[14:15], v[102:103] op_sel_hi:[1,0,1]
    v_pk_fma_f32 v[128:129], v[64:65], v[8:9], v[144:145] op_sel:[1,1,0] op_sel_hi:[0,1,1] neg_lo:[0,1,0]
    v_pk_fma_f32 v[132:133], v[66:67], v[10:11], v[146:147] op_sel:[1,1,0] op_sel_hi:[0,1,1] neg_lo:[0,1,0]
    v_pk_fma_f32 v[136:137], v[96:97], v[12:13], v[148:149] op_sel:[1,1,0] op_sel_hi:[0,1,1] neg_lo:[0,1,0]
    v_pk_fma_f32 v[140:141], v[98:99], v[14:15], v[150:151] op_sel:[1,1,0] op_sel_hi:[0,1,1] neg_lo:[0,1,0]
    v_pk_fma_f32 v[144:145], v[128:129], v[8:9], v[72:73] op_sel_hi:[1,0,1]
    v_pk_fma_f32 v[146:147], v[132:133], v[10:11], v[74:75] op_sel_hi:[1,0,1]
    v_pk_fma_f32 v[148:149], v[136:137], v[12:13], v[104:105] op_sel_hi:[1,0,1]
    v_pk_fma_f32 v[150:151], v[140:141], v[14:15], v[106:107] op_sel_hi:[1,0,1]
    v_pk_fma_f32 v[128:129], v[128:129], v[8:9], v[144:145] op_sel:[1,1,0] op_sel_hi:[0,1,1] neg_lo:[0,1,0]
    v_pk_fma_f32 v[132:133], v[132:133], v[10:11], v[146:147] op_sel:[1,1,0] op_sel_hi:[0,1,1] neg_lo:[0,1,0]
    v_pk_fma_f32 v[136:137], v[136:137], v[12:13], v[148:149] op_sel:[1,1,0] op_sel_hi:[0,1,1] neg_lo:[0,1,0]
    v_pk_fma_f32 v[140:141], v[140:141], v[14:15], v[150:151] op_sel:[1,1,0] op_sel_hi:[0,1,1] neg_lo:[0,1,0]
    v_pk_fma_f32 v[144:145], v[128:129], v[8:9], v[76:77] op_sel_hi:[1,0,1]
    v_pk_fma_f32 v[146:147], v[132:133], v[10:11], v[78:79] op_sel_hi:[1,0,1]
    v_pk_fma_f32 v[148:149], v[136:137], v[12:13], v[108:109] op_sel_hi:[1,0,1]
    v_pk_fma_f32 v[150:151], v[140:141], v[14:15], v[110:111] op_sel_hi:[1,0,1]
    v_pk_fma_f32 v[128:129], v[128:129], v[8:9], v[144:145] op_sel:[1,1,0] op_sel_hi:[0,1,1] neg_lo:[0,1,0]
    v_pk_fma_f32 v[132:133], v[132:133], v[10:11], v[146:147] op_sel:[1,1,0] op_sel_hi:[0,1,1] neg_lo:[0,1,0]
    v_pk_fma_f32 v[136:137], v[136:137], v[12:13], v[148:149] op_sel:[1,1,0] op_sel_hi:[0,1,1] neg_lo:[0,1,0]
    v_pk_fma_f32 v[140:141], v[140:141], v[14:15], v[150:151] op_sel:[1,1,0] op_sel_hi:[0,1,1] neg_lo:[0,1,0]
    v_pk_fma_f32 v[144:145], v[128:129], v[8:9], v[80:81] op_sel_hi:[1,0,1]
    v_pk_fma_f32 v[146:147], v[132:133], v[10:11], v[82:83] op_sel_hi:[1,0,1]
    v_pk_fma_f32 v[148:149], v[136:137], v[12:13], v[112:113] op_sel_hi:[1,0,1]
    v_pk_fma_f32 v[150:151], v[140:141], v[14:15], v[114:115] op_sel_hi:[1,0,1]
    v_pk_fma_f32 v[128:129], v[128:129], v[8:9], v[144:145] op_sel:[1,1,0] op_sel_hi:[0,1,1] neg_lo:[0,1,0]
    v_pk_fma_f32 v[132:133], v[132:133], v[10:11], v[146:147] op_sel:[1,1,0] op_sel_hi:[0,1,1] neg_lo:[0,1,0]
    v_pk_fma_f32 v[136:137], v[136:137], v[12:13], v[148:149] op_sel:[1,1,0] op_sel_hi:[0,1,1] neg_lo:[0,1,0]
    v_pk_fma_f32 v[140:141], v[140:141], v[14:15], v[150:151] op_sel:[1,1,0] op_sel_hi:[0,1,1] neg_lo:[0,1,0]
    v_pk_fma_f32 v[144:145], v[128:129], v[8:9], v[84:85] op_sel_hi:[1,0,1]
    v_pk_fma_f32 v[146:147], v[132:133], v[10:11], v[86:87] op_sel_hi:[1,0,1]
    v_pk_fma_f32 v[148:149], v[136:137], v[12:13], v[116:117] op_sel_hi:[1,0,1]
    v_pk_fma_f32 v[150:151], v[140:141], v[14:15], v[118:119] op_sel_hi:[1,0,1]
    v_pk_fma_f32 v[128:129], v[128:129], v[8:9], v[144:145] op_sel:[1,1,0] op_sel_hi:[0,1,1] neg_lo:[0,1,0]
    v_pk_fma_f32 v[132:133], v[132:133], v[10:11], v[146:147] op_sel:[1,1,0] op_sel_hi:[0,1,1] neg_lo:[0,1,0]
    v_pk_fma_f32 v[136:137], v[136:137], v[12:13], v[148:149] op_sel:[1,1,0] op_sel_hi:[0,1,1] neg_lo:[0,1,0]
    v_pk_fma_f32 v[140:141], v[140:141], v[14:15], v[150:151] op_sel:[1,1,0] op_sel_hi:[0,1,1] neg_lo:[0,1,0]
    v_pk_fma_f32 v[144:145], v[128:129], v[8:9], v[88:89] op_sel_hi:[1,0,1]
    v_pk_fma_f32 v[146:147], v[132:133], v[10:11], v[90:91] op_sel_hi:[1,0,1]
    v_pk_fma_f32 v[148:149], v[136:137], v[12:13], v[120:121] op_sel_hi:[1,0,1]
    v_pk_fma_f32 v[150:151], v[140:141], v[14:15], v[122:123] op_sel_hi:[1,0,1]
    v_pk_fma_f32 v[128:129], v[128:129], v[8:9], v[144:145] op_sel:[1,1,0] op_sel_hi:[0,1,1] neg_lo:[0,1,0]
    v_pk_fma_f32 v[132:133], v[132:133], v[10:11], v[146:147] op_sel:[1,1,0] op_sel_hi:[0,1,1] neg_lo:[0,1,0]
    v_pk_fma_f32 v[136:137], v[136:137], v[12:13], v[148:149] op_sel:[1,1,0] op_sel_hi:[0,1,1] neg_lo:[0,1,0]
    v_pk_fma_f32 v[140:141], v[140:141], v[14:15], v[150:151] op_sel:[1,1,0] op_sel_hi:[0,1,1] neg_lo:[0,1,0]
    v_pk_fma_f32 v[144:145], v[128:129], v[8:9], v[92:93] op_sel_hi:[1,0,1]
    v_pk_fma_f32 v[146:147], v[132:133], v[10:11], v[94:95] op_sel_hi:[1,0,1]
    v_pk_fma_f32 v[148:149], v[136:137], v[12:13], v[124:125] op_sel_hi:[1,0,1]
    v_pk_fma_f32 v[150:151], v[140:141], v[14:15], v[126:127] op_sel_hi:[1,0,1]
    v_pk_fma_f32 v[128:129], v[128:129], v[8:9], v[144:145] op_sel:[1,1,0] op_sel_hi:[0,1,1] neg_lo:[0,1,0]
    v_pk_fma_f32 v[132:133], v[132:133], v[10:11], v[146:147] op_sel:[1,1,0] op_sel_hi:[0,1,1] neg_lo:[0,1,0]
    v_pk_fma_f32 v[136:137], v[136:137], v[12:13], v[148:149] op_sel:[1,1,0] op_sel_hi:[0,1,1] neg_lo:[0,1,0]
    v_pk_fma_f32 v[140:141], v[140:141], v[14:15], v[150:151] op_sel:[1,1,0] op_sel_hi:[0,1,1] neg_lo:[0,1,0]
    v_mov_b32_dpp v152, v128 row_shr:1 row_mask:0xf bank_mask:0xf bound_ctrl:0
    v_mov_b32_dpp v154, v132 row_shr:1 row_mask:0xf bank_mask:0xf bound_ctrl:0
    v_mov_b32_dpp v156, v136 row_shr:1 row_mask:0xf bank_mask:0xf bound_ctrl:0
    v_mov_b32_dpp v158, v140 row_shr:1 row_mask:0xf bank_mask:0xf bound_ctrl:0
    v_mov_b32_dpp v153, v129 row_shr:1 row_mask:0xf bank_mask:0xf bound_ctrl:0
    v_mov_b32_dpp v155, v133 row_shr:1 row_mask:0xf bank_mask:0xf bound_ctrl:0
    v_mov_b32_dpp v157, v137 row_shr:1 row_mask:0xf bank_mask:0xf bound_ctrl:0
    v_mov_b32_dpp v159, v141 row_shr:1 row_mask:0xf bank_mask:0xf bound_ctrl:0
    v_pk_fma_f32 v[128:129], v[152:153], v[16:17], v[128:129] op_sel_hi:[1,0,1]
    v_pk_fma_f32 v[132:133], v[154:155], v[18:19], v[132:133] op_sel_hi:[1,0,1]
    v_pk_fma_f32 v[136:137], v[156:157], v[20:21], v[136:137] op_sel_hi:[1,0,1]
    v_pk_fma_f32 v[140:141], v[158:159], v[22:23], v[140:141] op_sel_hi:[1,0,1]
    v_pk_fma_f32 v[128:129], v[152:153], v[16:17], v[128:129] op_sel:[1,1,0] op_sel_hi:[0,1,1] neg_lo:[0,1,0]
    v_pk_fma_f32 v[132:133], v[154:155], v[18:19], v[132:133] op_sel:[1,1,0] op_sel_hi:[0,1,1] neg_lo:[0,1,0]
    v_pk_fma_f32 v[136:137], v[156:157], v[20:21], v[136:137] op_sel:[1,1,0] op_sel_hi:[0,1,1] neg_lo:[0,1,0]
    v_pk_fma_f32 v[140:141], v[158:159], v[22:23], v[140:141] op_sel:[1,1,0] op_sel_hi:[0,1,1] neg_lo:[0,1,0]
    v_mov_b32_dpp v152, v128 row_shr:2 row_mask:0xf bank_mask:0xf bound_ctrl:0
    v_mov_b32_dpp v154, v132 row_shr:2 row_mask:0xf bank_mask:0xf bound_ctrl:0
    v_mov_b32_dpp v156, v136 row_shr:2 row_mask:0xf bank_mask:0xf bound_ctrl:0
    v_mov_b32_dpp v158, v140 row_shr:2 row_mask:0xf bank_mask:0xf bound_ctrl:0
    v_mov_b32_dpp v153, v129 row_shr:2 row_mask:0xf bank_mask:0xf bound_ctrl:0
    v_mov_b32_dpp v155, v133 row_shr:2 row_mask:0xf bank_mask:0xf bound_ctrl:0
    v_mov_b32_dpp v157, v137 row_shr:2 row_mask:0xf bank_mask:0xf bound_ctrl:0
    v_mov_b32_dpp v159, v141 row_shr:2 row_mask:0xf bank_mask:0xf bound_ctrl:0
    v_pk_fma_f32 v[128:129], v[152:153], v[24:25], v[128:129] op_sel_hi:[1,0,1]
    v_pk_fma_f32 v[132:133], v[154:155], v[26:27], v[132:133] op_sel_hi:[1,0,1]
    v_pk_fma_f32 v[136:137], v[156:157], v[28:29], v[136:137] op_sel_hi:[1,0,1]
    v_pk_fma_f32 v[140:141], v[158:159], v[30:31], v[140:141] op_sel_hi:[1,0,1]
    v_pk_fma_f32 v[128:129], v[152:153], v[24:25], v[128:129] op_sel:[1,1,0] op_sel_hi:[0,1,1] neg_lo:[0,1,0]
    v_pk_fma_f32 v[132:133], v[154:155], v[26:27], v[132:133] op_sel:[1,1,0] op_sel_hi:[0,1,1] neg_lo:[0,1,0]
    v_pk_fma_f32 v[136:137], v[156:157], v[28:29], v[136:137] op_sel:[1,1,0] op_sel_hi:[0,1,1] neg_lo:[0,1,0]
    v_pk_fma_f32 v[140:141], v[158:159], v[30:31], v[140:141] op_sel:[1,1,0] op_sel_hi:[0,1,1] neg_lo:[0,1,0]
    v_mov_b32_dpp v152, v128 row_shr:4 row_mask:0xf bank_mask:0xf bound_ctrl:0
    v_mov_b32_dpp v154, v132 row_shr:4 row_mask:0xf bank_mask:0xf bound_ctrl:0
    v_mov_b32_dpp v156, v136 row_shr:4 row_mask:0xf bank_mask:0xf bound_ctrl:0
    v_mov_b32_dpp v158, v140 row_shr:4 row_mask:0xf bank_mask:0xf bound_ctrl:0
    v_mov_b32_dpp v153, v129 row_shr:4 row_mask:0xf bank_mask:0xf bound_ctrl:0
    v_mov_b32_dpp v155, v133 row_shr:4 row_mask:0xf bank_mask:0xf bound_ctrl:0
    v_mov_b32_dpp v157, v137 row_shr:4 row_mask:0xf bank_mask:0xf bound_ctrl:0
    v_mov_b32_dpp v159, v141 row_shr:4 row_mask:0xf bank_mask:0xf bound_ctrl:0
    v_pk_fma_f32 v[128:129], v[152:153], v[32:33], v[128:129] op_sel_hi:[1,0,1]
    v_pk_fma_f32 v[132:133], v[154:155], v[34:35], v[132:133] op_sel_hi:[1,0,1]
    v_pk_fma_f32 v[136:137], v[156:157], v[36:37], v[136:137] op_sel_hi:[1,0,1]
    v_pk_fma_f32 v[140:141], v[158:159], v[38:39], v[140:141] op_sel_hi:[1,0,1]
    v_pk_fma_f32 v[128:129], v[152:153], v[32:33], v[128:129] op_sel:[1,1,0] op_sel_hi:[0,1,1] neg_lo:[0,1,0]
    v_pk_fma_f32 v[132:133], v[154:155], v[34:35], v[132:133] op_sel:[1,1,0] op_sel_hi:[0,1,1] neg_lo:[0,1,0]
    v_pk_fma_f32 v[136:137], v[156:157], v[36:37], v[136:137] op_sel:[1,1,0] op_sel_hi:[0,1,1] neg_lo:[0,1,0]
    v_pk_fma_f32 v[140:141], v[158:159], v[38:39], v[140:141] op_sel:[1,1,0] op_sel_hi:[0,1,1] neg_lo:[0,1,0]
    v_mov_b32_dpp v152, v128 row_shr:8 row_mask:0xf bank_mask:0xf bound_ctrl:0
    v_mov_b32_dpp v154, v132 row_shr:8 row_mask:0xf bank_mask:0xf bound_ctrl:0
    v_mov_b32_dpp v156, v136 row_shr:8 row_mask:0xf bank_mask:0xf bound_ctrl:0
    v_mov_b32_dpp v158, v140 row_shr:8 row_mask:0xf bank_mask:0xf bound_ctrl:0
    v_mov_b32_dpp v153, v129 row_shr:8 row_mask:0xf bank_mask:0xf bound_ctrl:0
    v_mov_b32_dpp v155, v133 row_shr:8 row_mask:0xf bank_mask:0xf bound_ctrl:0
    v_mov_b32_dpp v157, v137 row_shr:8 row_mask:0xf bank_mask:0xf bound_ctrl:0
    v_mov_b32_dpp v159, v141 row_shr:8 row_mask:0xf bank_mask:0xf bound_ctrl:0
    v_pk_fma_f32 v[128:129], v[152:153], v[40:41], v[128:129] op_sel_hi:[1,0,1]
    v_pk_fma_f32 v[132:133], v[154:155], v[42:43], v[132:133] op_sel_hi:[1,0,1]
    v_pk_fma_f32 v[136:137], v[156:157], v[44:45], v[136:137] op_sel_hi:[1,0,1]
    v_pk_fma_f32 v[140:141], v[158:159], v[46:47], v[140:141] op_sel_hi:[1,0,1]
    v_pk_fma_f32 v[128:129], v[152:153], v[40:41], v[128:129] op_sel:[1,1,0] op_sel_hi:[0,1,1] neg_lo:[0,1,0]
    v_pk_fma_f32 v[132:133], v[154:155], v[42:43], v[132:133] op_sel:[1,1,0] op_sel_hi:[0,1,1] neg_lo:[0,1,0]
    v_pk_fma_f32 v[136:137], v[156:157], v[44:45], v[136:137] op_sel:[1,1,0] op_sel_hi:[0,1,1] neg_lo:[0,1,0]
    v_pk_fma_f32 v[140:141], v[158:159], v[46:47], v[140:141] op_sel:[1,1,0] op_sel_hi:[0,1,1] neg_lo:[0,1,0]
    s_lshl_b32 s76, s7, 2
    s_add_u32 s76, s76, s10
    s_lshl_b32 s11, s76, 12
    s_add_u32 s11, s11, 0x10000
    s_lshl_b32 s77, s6, 8
    s_add_u32 s77, s77, s11
    v_lshlrev_b32 v160, 6, v2
    v_cmp_eq_u32 vcc, 15, v1
    s_nop 0
    s_and_saveexec_b64 s[78:79], vcc
    buffer_store_dwordx4 v[128:131], v160, s[68:71], s77 offen offset:0 sc1
    buffer_store_dwordx4 v[132:135], v160, s[68:71], s77 offen offset:16 sc1
    buffer_store_dwordx4 v[136:139], v160, s[68:71], s77 offen offset:32 sc1
    buffer_store_dwordx4 v[140:143], v160, s[68:71], s77 offen offset:48 sc1
    s_mov_b64 exec, s[78:79]
    v_and_b32 v248, 7, v0
    v_lshlrev_b32 v248, 7, v248
    s_lshl_b32 s15, s8, 4
    s_add_u32 s15, s15, s6
    s_lshl_b32 s15, s15, 10
    s_add_u32 s15, s15, 0x8000
    buffer_load_dwordx4 v[244:247], v248, s[68:71], s15 offen sc1
    s_barrier
    s_lshl_b32 s76, s7, 7
    s_add_u32 s16, s76, 0
    s_add_u32 s17, s76, 32
    s_add_u32 s18, s76, 64
    s_add_u32 s19, s76, 96
    s_add_u32 s20, s76, 128
    s_add_u32 s21, s76, 160
    s_add_u32 s22, s76, 192
    s_add_u32 s23, s76, 224
    s_add_u32 s24, s76, 256
    s_add_u32 s25, s76, 288
    s_add_u32 s26, s76, 320
    s_add_u32 s27, s76, 352
    s_add_u32 s28, s76, 384
    s_add_u32 s29, s76, 416
    s_add_u32 s30, s76, 448
    s_add_u32 s31, s76, 480
    s_add_u32 s32, s76, 512
    s_add_u32 s33, s76, 544
    s_add_u32 s34, s76, 576
    s_add_u32 s35, s76, 608
    s_add_u32 s36, s76, 640
    s_add_u32 s37, s76, 672
    s_add_u32 s52, s76, 704
    s_add_u32 s53, s76, 736
    s_add_u32 s54, s76, 768
    s_add_u32 s55, s76, 800
    s_add_u32 s56, s76, 832
    s_add_u32 s57, s76, 864
    s_add_u32 s58, s76, 896
    s_add_u32 s59, s76, 928
    s_add_u32 s64, s76, 960
    s_add_u32 s65, s76, 992
    s_and_b32 s16, s16, 1023
    s_and_b32 s17, s17, 1023
    s_and_b32 s18, s18, 1023
    s_and_b32 s19, s19, 1023
    s_and_b32 s20, s20, 1023
    s_and_b32 s21, s21, 1023
    s_and_b32 s22, s22, 1023
    s_and_b32 s23, s23, 1023
    s_and_b32 s24, s24, 1023
    s_and_b32 s25, s25, 1023
    s_and_b32 s26, s26, 1023
    s_and_b32 s27, s27, 1023
    s_and_b32 s28, s28, 1023
    s_and_b32 s29, s29, 1023
    s_and_b32 s30, s30, 1023
    s_and_b32 s31, s31, 1023
    s_and_b32 s32, s32, 1023
    s_and_b32 s33, s33, 1023
    s_and_b32 s34, s34, 1023
    s_and_b32 s35, s35, 1023
    s_and_b32 s36, s36, 1023
    s_and_b32 s37, s37, 1023
    s_and_b32 s52, s52, 1023
    s_and_b32 s53, s53, 1023
    s_and_b32 s54, s54, 1023
    s_and_b32 s55, s55, 1023
    s_and_b32 s56, s56, 1023
    s_and_b32 s57, s57, 1023
    s_and_b32 s58, s58, 1023
    s_and_b32 s59, s59, 1023
    s_and_b32 s64, s64, 1023
    s_and_b32 s65, s65, 1023
    v_mov_b32_dpp v162, v128 row_shr:1 row_mask:0xf bank_mask:0xf bound_ctrl:0
    v_mov_b32_dpp v163, v129 row_shr:1 row_mask:0xf bank_mask:0xf bound_ctrl:0
    v_mov_b32_dpp v164, v132 row_shr:1 row_mask:0xf bank_mask:0xf bound_ctrl:0
    v_mov_b32_dpp v165, v133 row_shr:1 row_mask:0xf bank_mask:0xf bound_ctrl:0
    v_mov_b32_dpp v166, v136 row_shr:1 row_mask:0xf bank_mask:0xf bound_ctrl:0
    v_mov_b32_dpp v167, v137 row_shr:1 row_mask:0xf bank_mask:0xf bound_ctrl:0
    v_mov_b32_dpp v168, v140 row_shr:1 row_mask:0xf bank_mask:0xf bound_ctrl:0
    v_mov_b32_dpp v169, v141 row_shr:1 row_mask:0xf bank_mask:0xf bound_ctrl:0
    v_add_f32 v180, -1.0, v8
    v_add_f32 v184, -1.0, v10
    v_add_f32 v188, -1.0, v12
    v_add_f32 v192, -1.0, v14
    v_mul_f32 v181, v56, v56
    v_mul_f32 v185, v57, v57
    v_mul_f32 v189, v58, v58
    v_mul_f32 v193, v59, v59
    v_fmac_f32 v181, v60, v60
    v_fmac_f32 v185, v61, v61
    v_fmac_f32 v189, v62, v62
    v_fmac_f32 v193, v63, v63
    v_rcp_f32 v181, v181
    v_rcp_f32 v185, v185
    v_rcp_f32 v189, v189
    v_rcp_f32 v193, v193
    v_mul_f32 v182, v180, v56
    v_mul_f32 v186, v184, v57
    v_mul_f32 v190, v188, v58
    v_mul_f32 v194, v192, v59
    v_fmac_f32 v182, v9, v60
    v_fmac_f32 v186, v11, v61
    v_fmac_f32 v190, v13, v62
    v_fmac_f32 v194, v15, v63
    v_mul_f32 v183, v9, v56
    v_mul_f32 v187, v11, v57
    v_mul_f32 v191, v13, v58
    v_mul_f32 v195, v15, v59
    v_fma_f32 v183, -v180, v60, v183
    v_fma_f32 v187, -v184, v61, v187
    v_fma_f32 v191, -v188, v62, v191
    v_fma_f32 v195, -v192, v63, v195
    v_add_f32 v181, v181, v181
    v_add_f32 v185, v185, v185
    v_add_f32 v189, v189, v189
    v_add_f32 v193, v193, v193
    v_mul_f32 v170, v182, v181
    v_mul_f32 v172, v186, v185
    v_mul_f32 v174, v190, v189
    v_mul_f32 v176, v194, v193
    v_mul_f32 v171, v183, v181
    v_mul_f32 v173, v187, v185
    v_mul_f32 v175, v191, v189
    v_mul_f32 v177, v195, v193
    v_cvt_f32_u32 v212, v1
    v_mul_f32 v212, 0x41000000, v212
    s_sub_u32 s76, s6, 1
    v_sub_u32 v213, s76, v1
    v_max_i32 v213, 0, v213
    v_cvt_f32_i32 v213, v213
    v_mul_f32 v213, 0x43000000, v213
    v_mul_f32 v216, v212, v48
    v_mul_f32 v219, v212, v49
    v_mul_f32 v222, v212, v50
    v_mul_f32 v225, v212, v51
    v_mul_f32 v217, v212, v52
    v_mul_f32 v220, v212, v53
    v_mul_f32 v223, v212, v54
    v_mul_f32 v226, v212, v55
    v_exp_f32 v216, v216
    v_exp_f32 v219, v219
    v_exp_f32 v222, v222
    v_exp_f32 v225, v225
    v_fract_f32 v217, v217
    v_fract_f32 v220, v220
    v_fract_f32 v223, v223
    v_fract_f32 v226, v226
    v_cos_f32 v218, v217
    v_cos_f32 v221, v220
    v_cos_f32 v224, v223
    v_cos_f32 v227, v226
    v_sin_f32 v217, v217
    v_sin_f32 v220, v220
    v_sin_f32 v223, v223
    v_sin_f32 v226, v226
    v_mul_f32 v196, v216, v218
    v_mul_f32 v198, v219, v221
    v_mul_f32 v200, v222, v224
    v_mul_f32 v202, v225, v227
    v_mul_f32 v197, v216, v217
    v_mul_f32 v199, v219, v220
    v_mul_f32 v201, v222, v223
    v_mul_f32 v203, v225, v226
    v_mul_f32 v216, v213, v48
    v_mul_f32 v219, v213, v49
    v_mul_f32 v222, v213, v50
    v_mul_f32 v225, v213, v51
    v_mul_f32 v217, v213, v52
    v_mul_f32 v220, v213, v53
    v_mul_f32 v223, v213, v54
    v_mul_f32 v226, v213, v55
    v_exp_f32 v216, v216
    v_exp_f32 v219, v219
    v_exp_f32 v222, v222
    v_exp_f32 v225, v225
    v_fract_f32 v217, v217
    v_fract_f32 v220, v220
    v_fract_f32 v223, v223
    v_fract_f32 v226, v226
    v_cos_f32 v218, v217
    v_cos_f32 v221, v220
    v_cos_f32 v224, v223
    v_cos_f32 v227, v226
    v_sin_f32 v217, v217
    v_sin_f32 v220, v220
    v_sin_f32 v223, v223
    v_sin_f32 v226, v226
    v_mul_f32 v204, v216, v218
    v_mul_f32 v206, v219, v221
    v_mul_f32 v208, v222, v224
    v_mul_f32 v210, v225, v227
    v_mul_f32 v205, v216, v217
    v_mul_f32 v207, v219, v220
    v_mul_f32 v209, v222, v223
    v_mul_f32 v211, v225, v226
    v_pk_mul_f32 v[228:229], v[64:65], v[170:171] op_sel_hi:[1,0]
    v_pk_mul_f32 v[230:231], v[66:67], v[172:173] op_sel_hi:[1,0]
    v_pk_mul_f32 v[232:233], v[96:97], v[174:175] op_sel_hi:[1,0]
    v_pk_mul_f32 v[234:235], v[98:99], v[176:177] op_sel_hi:[1,0]
    v_pk_fma_f32 v[64:65], v[64:65], v[170:171], v[228:229] op_sel:[1,1,0] op_sel_hi:[0,1,1] neg_lo:[0,1,0]
    v_pk_fma_f32 v[66:67], v[66:67], v[172:173], v[230:231] op_sel:[1,1,0] op_sel_hi:[0,1,1] neg_lo:[0,1,0]
    v_pk_fma_f32 v[96:97], v[96:97], v[174:175], v[232:233] op_sel:[1,1,0] op_sel_hi:[0,1,1] neg_lo:[0,1,0]
    v_pk_fma_f32 v[98:99], v[98:99], v[176:177], v[234:235] op_sel:[1,1,0] op_sel_hi:[0,1,1] neg_lo:[0,1,0]
    v_pk_mul_f32 v[228:229], v[68:69], v[170:171] op_sel_hi:[1,0]
    v_pk_mul_f32 v[230:231], v[70:71], v[172:173] op_sel_hi:[1,0]
    v_pk_mul_f32 v[232:233], v[100:101], v[174:175] op_sel_hi:[1,0]
    v_pk_mul_f32 v[234:235], v[102:103], v[176:177] op_sel_hi:[1,0]
    v_pk_fma_f32 v[68:69], v[68:69], v[170:171], v[228:229] op_sel:[1,1,0] op_sel_hi:[0,1,1] neg_lo:[0,1,0]
    v_pk_fma_f32 v[70:71], v[70:71], v[172:173], v[230:231] op_sel:[1,1,0] op_sel_hi:[0,1,1] neg_lo:[0,1,0]
    v_pk_fma_f32 v[100:101], v[100:101], v[174:175], v[232:233] op_sel:[1,1,0] op_sel_hi:[0,1,1] neg_lo:[0,1,0]
    v_pk_fma_f32 v[102:103], v[102:103], v[176:177], v[234:235] op_sel:[1,1,0] op_sel_hi:[0,1,1] neg_lo:[0,1,0]
    v_pk_mul_f32 v[228:229], v[72:73], v[170:171] op_sel_hi:[1,0]
    v_pk_mul_f32 v[230:231], v[74:75], v[172:173] op_sel_hi:[1,0]
    v_pk_mul_f32 v[232:233], v[104:105], v[174:175] op_sel_hi:[1,0]
    v_pk_mul_f32 v[234:235], v[106:107], v[176:177] op_sel_hi:[1,0]
    v_pk_fma_f32 v[72:73], v[72:73], v[170:171], v[228:229] op_sel:[1,1,0] op_sel_hi:[0,1,1] neg_lo:[0,1,0]
    v_pk_fma_f32 v[74:75], v[74:75], v[172:173], v[230:231] op_sel:[1,1,0] op_sel_hi:[0,1,1] neg_lo:[0,1,0]
    v_pk_fma_f32 v[104:105], v[104:105], v[174:175], v[232:233] op_sel:[1,1,0] op_sel_hi:[0,1,1] neg_lo:[0,1,0]
    v_pk_fma_f32 v[106:107], v[106:107], v[176:177], v[234:235] op_sel:[1,1,0] op_sel_hi:[0,1,1] neg_lo:[0,1,0]
    v_pk_mul_f32 v[228:229], v[76:77], v[170:171] op_sel_hi:[1,0]
    v_pk_mul_f32 v[230:231], v[78:79], v[172:173] op_sel_hi:[1,0]
    v_pk_mul_f32 v[232:233], v[108:109], v[174:175] op_sel_hi:[1,0]
    v_pk_mul_f32 v[234:235], v[110:111], v[176:177] op_sel_hi:[1,0]
    v_pk_fma_f32 v[76:77], v[76:77], v[170:171], v[228:229] op_sel:[1,1,0] op_sel_hi:[0,1,1] neg_lo:[0,1,0]
    v_pk_fma_f32 v[78:79], v[78:79], v[172:173], v[230:231] op_sel:[1,1,0] op_sel_hi:[0,1,1] neg_lo:[0,1,0]
    v_pk_fma_f32 v[108:109], v[108:109], v[174:175], v[232:233] op_sel:[1,1,0] op_sel_hi:[0,1,1] neg_lo:[0,1,0]
    v_pk_fma_f32 v[110:111], v[110:111], v[176:177], v[234:235] op_sel:[1,1,0] op_sel_hi:[0,1,1] neg_lo:[0,1,0]
    v_pk_mul_f32 v[228:229], v[80:81], v[170:171] op_sel_hi:[1,0]
    v_pk_mul_f32 v[230:231], v[82:83], v[172:173] op_sel_hi:[1,0]
    v_pk_mul_f32 v[232:233], v[112:113], v[174:175] op_sel_hi:[1,0]
    v_pk_mul_f32 v[234:235], v[114:115], v[176:177] op_sel_hi:[1,0]
    v_pk_fma_f32 v[80:81], v[80:81], v[170:171], v[228:229] op_sel:[1,1,0] op_sel_hi:[0,1,1] neg_lo:[0,1,0]
    v_pk_fma_f32 v[82:83], v[82:83], v[172:173], v[230:231] op_sel:[1,1,0] op_sel_hi:[0,1,1] neg_lo:[0,1,0]
    v_pk_fma_f32 v[112:113], v[112:113], v[174:175], v[232:233] op_sel:[1,1,0] op_sel_hi:[0,1,1] neg_lo:[0,1,0]
    v_pk_fma_f32 v[114:115], v[114:115], v[176:177], v[234:235] op_sel:[1,1,0] op_sel_hi:[0,1,1] neg_lo:[0,1,0]
    v_pk_mul_f32 v[228:229], v[84:85], v[170:171] op_sel_hi:[1,0]
    v_pk_mul_f32 v[230:231], v[86:87], v[172:173] op_sel_hi:[1,0]
    v_pk_mul_f32 v[232:233], v[116:117], v[174:175] op_sel_hi:[1,0]
    v_pk_mul_f32 v[234:235], v[118:119], v[176:177] op_sel_hi:[1,0]
    v_pk_fma_f32 v[84:85], v[84:85], v[170:171], v[228:229] op_sel:[1,1,0] op_sel_hi:[0,1,1] neg_lo:[0,1,0]
    v_pk_fma_f32 v[86:87], v[86:87], v[172:173], v[230:231] op_sel:[1,1,0] op_sel_hi:[0,1,1] neg_lo:[0,1,0]
    v_pk_fma_f32 v[116:117], v[116:117], v[174:175], v[232:233] op_sel:[1,1,0] op_sel_hi:[0,1,1] neg_lo:[0,1,0]
    v_pk_fma_f32 v[118:119], v[118:119], v[176:177], v[234:235] op_sel:[1,1,0] op_sel_hi:[0,1,1] neg_lo:[0,1,0]
    v_pk_mul_f32 v[228:229], v[88:89], v[170:171] op_sel_hi:[1,0]
    v_pk_mul_f32 v[230:231], v[90:91], v[172:173] op_sel_hi:[1,0]
    v_pk_mul_f32 v[232:233], v[120:121], v[174:175] op_sel_hi:[1,0]
    v_pk_mul_f32 v[234:235], v[122:123], v[176:177] op_sel_hi:[1,0]
    v_pk_fma_f32 v[88:89], v[88:89], v[170:171], v[228:229] op_sel:[1,1,0] op_sel_hi:[0,1,1] neg_lo:[0,1,0]
    v_pk_fma_f32 v[90:91], v[90:91], v[172:173], v[230:231] op_sel:[1,1,0] op_sel_hi:[0,1,1] neg_lo:[0,1,0]
    v_pk_fma_f32 v[120:121], v[120:121], v[174:175], v[232:233] op_sel:[1,1,0] op_sel_hi:[0,1,1] neg_lo:[0,1,0]
    v_pk_fma_f32 v[122:123], v[122:123], v[176:177], v[234:235] op_sel:[1,1,0] op_sel_hi:[0,1,1] neg_lo:[0,1,0]
    v_pk_mul_f32 v[228:229], v[92:93], v[170:171] op_sel_hi:[1,0]
    v_pk_mul_f32 v[230:231], v[94:95], v[172:173] op_sel_hi:[1,0]
    v_pk_mul_f32 v[232:233], v[124:125], v[174:175] op_sel_hi:[1,0]
    v_pk_mul_f32 v[234:235], v[126:127], v[176:177] op_sel_hi:[1,0]
    v_pk_fma_f32 v[92:93], v[92:93], v[170:171], v[228:229] op_sel:[1,1,0] op_sel_hi:[0,1,1] neg_lo:[0,1,0]
    v_pk_fma_f32 v[94:95], v[94:95], v[172:173], v[230:231] op_sel:[1,1,0] op_sel_hi:[0,1,1] neg_lo:[0,1,0]
    v_pk_fma_f32 v[124:125], v[124:125], v[174:175], v[232:233] op_sel:[1,1,0] op_sel_hi:[0,1,1] neg_lo:[0,1,0]
    v_pk_fma_f32 v[126:127], v[126:127], v[176:177], v[234:235] op_sel:[1,1,0] op_sel_hi:[0,1,1] neg_lo:[0,1,0]
    v_lshlrev_b32 v3, 4, v0
    v_lshrrev_b32 v216, 1, v2
    v_xor_b32 v216, v216, v1
    v_lshlrev_b32 v216, 4, v216
    v_and_b32 v225, 1, v2
    v_lshl_add_u32 v216, v225, 10, v216
    v_lshl_add_u32 v216, v1, 13, v216
    s_lshl_b32 s76, s10, 11
    v_add_u32 v219, s76, v3
    v_add_u32 v224, 131072, v219
    s_lshl_b32 s76, s6, 18
    s_add_u32 s76, s76, 0x400000
    v_add_u32 v219, s76, v219
    v_lshlrev_b32 v226, 15, v2
    v_lshl_add_u32 v226, v1, 3, v226
    s_lshl_b32 s13, s6, 17
    s_lshl_b32 s76, s10, 11
    s_add_u32 s13, s13, s76
    s_lshl_b32 s76, s7, 7
    s_add_u32 s13, s13, s76
    v_lshlrev_b32 v227, 3, v1
    s_lshl_b32 s76, s7, 7
    v_add_u32 v227, s76, v227
    v_mov_b32 v128, 0
    v_mov_b32 v129, 0
    v_mov_b32 v132, 0
    v_mov_b32 v133, 0
    v_mov_b32 v136, 0
    v_mov_b32 v137, 0
    v_mov_b32 v140, 0
    v_mov_b32 v141, 0
    v_lshlrev_b32 v161, 8, v1
    v_add_u32 v161, v161, v160
    v_cmp_gt_u32 vcc, s6, v1
    s_nop 0
    s_mov_b64 s[78:79], vcc
    s_cmp_eq_u32 s6, 0
    s_cbranch_scc1 L_B_noissue
    s_mov_b64 exec, s[78:79]
    buffer_load_dwordx4 v[128:131], v161, s[68:71], s11 offen offset:0 sc1
    buffer_load_dwordx4 v[132:135], v161, s[68:71], s11 offen offset:16 sc1
    buffer_load_dwordx4 v[136:139], v161, s[68:71], s11 offen offset:32 sc1
    buffer_load_dwordx4 v[140:143], v161, s[68:71], s11 offen offset:48 sc1
    s_mov_b64 exec, -1
L_B_noissue:
    s_cmp_eq_u32 s6, 0
    s_cbranch_scc1 L_B_nopoll
    s_mov_b64 exec, s[78:79]
    s_mov_b32 s3, 0
L_B_poll:
    s_waitcnt vmcnt(0)
    v_cmp_ne_u64 vcc, s[46:47], v[130:131]
    v_cmp_ne_u64 s[76:77], s[46:47], v[134:135]
    s_nop 0
    s_or_b64 vcc, vcc, s[76:77]
    v_cmp_ne_u64 s[76:77], s[46:47], v[138:139]
    s_nop 0
    s_or_b64 vcc, vcc, s[76:77]
    v_cmp_ne_u64 s[76:77], s[46:47], v[142:143]
    s_nop 0
    s_or_b64 vcc, vcc, s[76:77]
    s_cmp_eq_u64 vcc, 0
    s_cbranch_scc1 L_B_polldone
    s_add_u32 s3, s3, 1
    s_cmp_ge_u32 s3, 1048576
    s_cbranch_scc1 L_B_polldone
    buffer_load_dwordx4 v[128:131], v161, s[68:71], s11 offen offset:0 sc1
    buffer_load_dwordx4 v[132:135], v161, s[68:71], s11 offen offset:16 sc1
    buffer_load_dwordx4 v[136:139], v161, s[68:71], s11 offen offset:32 sc1
    buffer_load_dwordx4 v[140:143], v161, s[68:71], s11 offen offset:48 sc1
    s_branch L_B_poll
L_B_polldone:
    s_mov_b64 exec, -1
L_B_nopoll:
    s_waitcnt vmcnt(0)
    s_mov_b32 s3, 0
L_B_xchk:
    v_cmp_ne_u64 vcc, s[46:47], v[246:247]
    s_nop 0
    s_cmp_eq_u64 vcc, 0
    s_cbranch_scc1 L_B_xok
    s_add_u32 s3, s3, 1
    s_cmp_ge_u32 s3, 1048576
    s_cbranch_scc1 L_B_xok
    buffer_load_dwordx4 v[244:247], v248, s[68:71], s15 offen sc1
    s_waitcnt vmcnt(0)
    s_branch L_B_xchk
L_B_xok:
    s_getreg_b32 s76, hwreg(HW_REG_XCC_ID)
    s_and_b32 s76, s76, 15
    v_cmp_ne_u32 vcc, s76, v244
    s_mov_b32 s14, 0
    s_cmp_eq_u64 vcc, 0
    s_cselect_b32 s14, 1, 0
    v_pk_mul_f32 v[228:229], v[128:129], v[204:205] op_sel_hi:[1,0]
    v_pk_mul_f32 v[230:231], v[132:133], v[206:207] op_sel_hi:[1,0]
    v_pk_mul_f32 v[232:233], v[136:137], v[208:209] op_sel_hi:[1,0]
    v_pk_mul_f32 v[234:235], v[140:141], v[210:211] op_sel_hi:[1,0]
    v_pk_fma_f32 v[236:237], v[128:129], v[204:205], v[228:229] op_sel:[1,1,0] op_sel_hi:[0,1,1] neg_lo:[0,1,0]
    v_pk_fma_f32 v[238:239], v[132:133], v[206:207], v[230:231] op_sel:[1,1,0] op_sel_hi:[0,1,1] neg_lo:[0,1,0]
    v_pk_fma_f32 v[240:241], v[136:137], v[208:209], v[232:233] op_sel:[1,1,0] op_sel_hi:[0,1,1] neg_lo:[0,1,0]
    v_pk_fma_f32 v[242:243], v[140:141], v[210:211], v[234:235] op_sel:[1,1,0] op_sel_hi:[0,1,1] neg_lo:[0,1,0]
    v_add_f32_dpp v236, v236, v236 row_ror:8 row_mask:0xf bank_mask:0xf
    v_add_f32_dpp v237, v237, v237 row_ror:8 row_mask:0xf bank_mask:0xf
    v_add_f32_dpp v238, v238, v238 row_ror:8 row_mask:0xf bank_mask:0xf
    v_add_f32_dpp v239, v239, v239 row_ror:8 row_mask:0xf bank_mask:0xf
    v_add_f32_dpp v240, v240, v240 row_ror:8 row_mask:0xf bank_mask:0xf
    v_add_f32_dpp v241, v241, v241 row_ror:8 row_mask:0xf bank_mask:0xf
    v_add_f32_dpp v242, v242, v242 row_ror:8 row_mask:0xf bank_mask:0xf
    v_add_f32_dpp v243, v243, v243 row_ror:8 row_mask:0xf bank_mask:0xf
    v_add_f32_dpp v236, v236, v236 row_ror:4 row_mask:0xf bank_mask:0xf
    v_add_f32_dpp v237, v237, v237 row_ror:4 row_mask:0xf bank_mask:0xf
    v_add_f32_dpp v238, v238, v238 row_ror:4 row_mask:0xf bank_mask:0xf
    v_add_f32_dpp v239, v239, v239 row_ror:4 row_mask:0xf bank_mask:0xf
    v_add_f32_dpp v240, v240, v240 row_ror:4 row_mask:0xf bank_mask:0xf
    v_add_f32_dpp v241, v241, v241 row_ror:4 row_mask:0xf bank_mask:0xf
    v_add_f32_dpp v242, v242, v242 row_ror:4 row_mask:0xf bank_mask:0xf
    v_add_f32_dpp v243, v243, v243 row_ror:4 row_mask:0xf bank_mask:0xf
    v_add_f32_dpp v236, v236, v236 row_ror:2 row_mask:0xf bank_mask:0xf
    v_add_f32_dpp v237, v237, v237 row_ror:2 row_mask:0xf bank_mask:0xf
    v_add_f32_dpp v238, v238, v238 row_ror:2 row_mask:0xf bank_mask:0xf
    v_add_f32_dpp v239, v239, v239 row_ror:2 row_mask:0xf bank_mask:0xf
    v_add_f32_dpp v240, v240, v240 row_ror:2 row_mask:0xf bank_mask:0xf
    v_add_f32_dpp v241, v241, v241 row_ror:2 row_mask:0xf bank_mask:0xf
    v_add_f32_dpp v242, v242, v242 row_ror:2 row_mask:0xf bank_mask:0xf
    v_add_f32_dpp v243, v243, v243 row_ror:2 row_mask:0xf bank_mask:0xf
    v_add_f32_dpp v236, v236, v236 row_ror:1 row_mask:0xf bank_mask:0xf
    v_add_f32_dpp v237, v237, v237 row_ror:1 row_mask:0xf bank_mask:0xf
    v_add_f32_dpp v238, v238, v238 row_ror:1 row_mask:0xf bank_mask:0xf
    v_add_f32_dpp v239, v239, v239 row_ror:1 row_mask:0xf bank_mask:0xf
    v_add_f32_dpp v240, v240, v240 row_ror:1 row_mask:0xf bank_mask:0xf
    v_add_f32_dpp v241, v241, v241 row_ror:1 row_mask:0xf bank_mask:0xf
    v_add_f32_dpp v242, v242, v242 row_ror:1 row_mask:0xf bank_mask:0xf
    v_add_f32_dpp v243, v243, v243 row_ror:1 row_mask:0xf bank_mask:0xf
    v_pk_fma_f32 v[162:163], v[236:237], v[196:197], v[162:163] op_sel_hi:[1,0,1]
    v_pk_fma_f32 v[164:165], v[238:239], v[198:199], v[164:165] op_sel_hi:[1,0,1]
    v_pk_fma_f32 v[166:167], v[240:241], v[200:201], v[166:167] op_sel_hi:[1,0,1]
    v_pk_fma_f32 v[168:169], v[242:243], v[202:203], v[168:169] op_sel_hi:[1,0,1]
    v_pk_fma_f32 v[162:163], v[236:237], v[196:197], v[162:163] op_sel:[1,1,0] op_sel_hi:[0,1,1] neg_lo:[0,1,0]
    v_pk_fma_f32 v[164:165], v[238:239], v[198:199], v[164:165] op_sel:[1,1,0] op_sel_hi:[0,1,1] neg_lo:[0,1,0]
    v_pk_fma_f32 v[166:167], v[240:241], v[200:201], v[166:167] op_sel:[1,1,0] op_sel_hi:[0,1,1] neg_lo:[0,1,0]
    v_pk_fma_f32 v[168:169], v[242:243], v[202:203], v[168:169] op_sel:[1,1,0] op_sel_hi:[0,1,1] neg_lo:[0,1,0]
    v_pk_mul_f32 v[228:229], v[162:163], v[170:171] op_sel_hi:[1,0]
    v_pk_mul_f32 v[230:231], v[164:165], v[172:173] op_sel_hi:[1,0]
    v_pk_mul_f32 v[232:233], v[166:167], v[174:175] op_sel_hi:[1,0]
    v_pk_mul_f32 v[234:235], v[168:169], v[176:177] op_sel_hi:[1,0]
    v_pk_fma_f32 v[162:163], v[162:163], v[170:171], v[228:229] op_sel:[1,1,0] op_sel_hi:[0,1,1] neg_lo:[0,1,0]
    v_pk_fma_f32 v[164:165], v[164:165], v[172:173], v[230:231] op_sel:[1,1,0] op_sel_hi:[0,1,1] neg_lo:[0,1,0]
    v_pk_fma_f32 v[166:167], v[166:167], v[174:175], v[232:233] op_sel:[1,1,0] op_sel_hi:[0,1,1] neg_lo:[0,1,0]
    v_pk_fma_f32 v[168:169], v[168:169], v[176:177], v[234:235] op_sel:[1,1,0] op_sel_hi:[0,1,1] neg_lo:[0,1,0]
    v_pk_fma_f32 v[64:65], v[162:163], v[8:9], v[64:65] op_sel_hi:[1,0,1]
    v_pk_fma_f32 v[66:67], v[164:165], v[10:11], v[66:67] op_sel_hi:[1,0,1]
    v_pk_fma_f32 v[96:97], v[166:167], v[12:13], v[96:97] op_sel_hi:[1,0,1]
    v_pk_fma_f32 v[98:99], v[168:169], v[14:15], v[98:99] op_sel_hi:[1,0,1]
    v_pk_fma_f32 v[64:65], v[162:163], v[8:9], v[64:65] op_sel:[1,1,0] op_sel_hi:[0,1,1] neg_lo:[0,1,0]
    v_pk_fma_f32 v[66:67], v[164:165], v[10:11], v[66:67] op_sel:[1,1,0] op_sel_hi:[0,1,1] neg_lo:[0,1,0]
    v_pk_fma_f32 v[96:97], v[166:167], v[12:13], v[96:97] op_sel:[1,1,0] op_sel_hi:[0,1,1] neg_lo:[0,1,0]
    v_pk_fma_f32 v[98:99], v[168:169], v[14:15], v[98:99] op_sel:[1,1,0] op_sel_hi:[0,1,1] neg_lo:[0,1,0]
    v_pk_fma_f32 v[68:69], v[64:65], v[8:9], v[68:69] op_sel_hi:[1,0,1]
    v_pk_fma_f32 v[70:71], v[66:67], v[10:11], v[70:71] op_sel_hi:[1,0,1]
    v_pk_fma_f32 v[100:101], v[96:97], v[12:13], v[100:101] op_sel_hi:[1,0,1]
    v_pk_fma_f32 v[102:103], v[98:99], v[14:15], v[102:103] op_sel_hi:[1,0,1]
    v_pk_fma_f32 v[68:69], v[64:65], v[8:9], v[68:69] op_sel:[1,1,0] op_sel_hi:[0,1,1] neg_lo:[0,1,0]
    v_pk_fma_f32 v[70:71], v[66:67], v[10:11], v[70:71] op_sel:[1,1,0] op_sel_hi:[0,1,1] neg_lo:[0,1,0]
    v_pk_fma_f32 v[100:101], v[96:97], v[12:13], v[100:101] op_sel:[1,1,0] op_sel_hi:[0,1,1] neg_lo:[0,1,0]
    v_pk_fma_f32 v[102:103], v[98:99], v[14:15], v[102:103] op_sel:[1,1,0] op_sel_hi:[0,1,1] neg_lo:[0,1,0]
    v_pk_fma_f32 v[72:73], v[68:69], v[8:9], v[72:73] op_sel_hi:[1,0,1]
    v_pk_fma_f32 v[74:75], v[70:71], v[10:11], v[74:75] op_sel_hi:[1,0,1]
    v_pk_fma_f32 v[104:105], v[100:101], v[12:13], v[104:105] op_sel_hi:[1,0,1]
    v_pk_fma_f32 v[106:107], v[102:103], v[14:15], v[106:107] op_sel_hi:[1,0,1]
    v_pk_fma_f32 v[72:73], v[68:69], v[8:9], v[72:73] op_sel:[1,1,0] op_sel_hi:[0,1,1] neg_lo:[0,1,0]
    v_pk_fma_f32 v[74:75], v[70:71], v[10:11], v[74:75] op_sel:[1,1,0] op_sel_hi:[0,1,1] neg_lo:[0,1,0]
    v_pk_fma_f32 v[104:105], v[100:101], v[12:13], v[104:105] op_sel:[1,1,0] op_sel_hi:[0,1,1] neg_lo:[0,1,0]
    v_pk_fma_f32 v[106:107], v[102:103], v[14:15], v[106:107] op_sel:[1,1,0] op_sel_hi:[0,1,1] neg_lo:[0,1,0]
    v_pk_fma_f32 v[76:77], v[72:73], v[8:9], v[76:77] op_sel_hi:[1,0,1]
    v_pk_fma_f32 v[78:79], v[74:75], v[10:11], v[78:79] op_sel_hi:[1,0,1]
    v_pk_fma_f32 v[108:109], v[104:105], v[12:13], v[108:109] op_sel_hi:[1,0,1]
    v_pk_fma_f32 v[110:111], v[106:107], v[14:15], v[110:111] op_sel_hi:[1,0,1]
    v_pk_fma_f32 v[76:77], v[72:73], v[8:9], v[76:77] op_sel:[1,1,0] op_sel_hi:[0,1,1] neg_lo:[0,1,0]
    v_pk_fma_f32 v[78:79], v[74:75], v[10:11], v[78:79] op_sel:[1,1,0] op_sel_hi:[0,1,1] neg_lo:[0,1,0]
    v_pk_fma_f32 v[108:109], v[104:105], v[12:13], v[108:109] op_sel:[1,1,0] op_sel_hi:[0,1,1] neg_lo:[0,1,0]
    v_pk_fma_f32 v[110:111], v[106:107], v[14:15], v[110:111] op_sel:[1,1,0] op_sel_hi:[0,1,1] neg_lo:[0,1,0]
    v_pk_fma_f32 v[80:81], v[76:77], v[8:9], v[80:81] op_sel_hi:[1,0,1]
    v_pk_fma_f32 v[82:83], v[78:79], v[10:11], v[82:83] op_sel_hi:[1,0,1]
    v_pk_fma_f32 v[112:113], v[108:109], v[12:13], v[112:113] op_sel_hi:[1,0,1]
    v_pk_fma_f32 v[114:115], v[110:111], v[14:15], v[114:115] op_sel_hi:[1,0,1]
    v_pk_fma_f32 v[80:81], v[76:77], v[8:9], v[80:81] op_sel:[1,1,0] op_sel_hi:[0,1,1] neg_lo:[0,1,0]
    v_pk_fma_f32 v[82:83], v[78:79], v[10:11], v[82:83] op_sel:[1,1,0] op_sel_hi:[0,1,1] neg_lo:[0,1,0]
    v_pk_fma_f32 v[112:113], v[108:109], v[12:13], v[112:113] op_sel:[1,1,0] op_sel_hi:[0,1,1] neg_lo:[0,1,0]
    v_pk_fma_f32 v[114:115], v[110:111], v[14:15], v[114:115] op_sel:[1,1,0] op_sel_hi:[0,1,1] neg_lo:[0,1,0]
    v_pk_fma_f32 v[84:85], v[80:81], v[8:9], v[84:85] op_sel_hi:[1,0,1]
    v_pk_fma_f32 v[86:87], v[82:83], v[10:11], v[86:87] op_sel_hi:[1,0,1]
    v_pk_fma_f32 v[116:117], v[112:113], v[12:13], v[116:117] op_sel_hi:[1,0,1]
    v_pk_fma_f32 v[118:119], v[114:115], v[14:15], v[118:119] op_sel_hi:[1,0,1]
    v_pk_fma_f32 v[84:85], v[80:81], v[8:9], v[84:85] op_sel:[1,1,0] op_sel_hi:[0,1,1] neg_lo:[0,1,0]
    v_pk_fma_f32 v[86:87], v[82:83], v[10:11], v[86:87] op_sel:[1,1,0] op_sel_hi:[0,1,1] neg_lo:[0,1,0]
    v_pk_fma_f32 v[116:117], v[112:113], v[12:13], v[116:117] op_sel:[1,1,0] op_sel_hi:[0,1,1] neg_lo:[0,1,0]
    v_pk_fma_f32 v[118:119], v[114:115], v[14:15], v[118:119] op_sel:[1,1,0] op_sel_hi:[0,1,1] neg_lo:[0,1,0]
    v_pk_fma_f32 v[88:89], v[84:85], v[8:9], v[88:89] op_sel_hi:[1,0,1]
    v_pk_fma_f32 v[90:91], v[86:87], v[10:11], v[90:91] op_sel_hi:[1,0,1]
    v_pk_fma_f32 v[120:121], v[116:117], v[12:13], v[120:121] op_sel_hi:[1,0,1]
    v_pk_fma_f32 v[122:123], v[118:119], v[14:15], v[122:123] op_sel_hi:[1,0,1]
    v_pk_fma_f32 v[88:89], v[84:85], v[8:9], v[88:89] op_sel:[1,1,0] op_sel_hi:[0,1,1] neg_lo:[0,1,0]
    v_pk_fma_f32 v[90:91], v[86:87], v[10:11], v[90:91] op_sel:[1,1,0] op_sel_hi:[0,1,1] neg_lo:[0,1,0]
    v_pk_fma_f32 v[120:121], v[116:117], v[12:13], v[120:121] op_sel:[1,1,0] op_sel_hi:[0,1,1] neg_lo:[0,1,0]
    v_pk_fma_f32 v[122:123], v[118:119], v[14:15], v[122:123] op_sel:[1,1,0] op_sel_hi:[0,1,1] neg_lo:[0,1,0]
    v_pk_fma_f32 v[92:93], v[88:89], v[8:9], v[92:93] op_sel_hi:[1,0,1]
    v_pk_fma_f32 v[94:95], v[90:91], v[10:11], v[94:95] op_sel_hi:[1,0,1]
    v_pk_fma_f32 v[124:125], v[120:121], v[12:13], v[124:125] op_sel_hi:[1,0,1]
    v_pk_fma_f32 v[126:127], v[122:123], v[14:15], v[126:127] op_sel_hi:[1,0,1]
    v_pk_fma_f32 v[92:93], v[88:89], v[8:9], v[92:93] op_sel:[1,1,0] op_sel_hi:[0,1,1] neg_lo:[0,1,0]
    v_pk_fma_f32 v[94:95], v[90:91], v[10:11], v[94:95] op_sel:[1,1,0] op_sel_hi:[0,1,1] neg_lo:[0,1,0]
    v_pk_fma_f32 v[124:125], v[120:121], v[12:13], v[124:125] op_sel:[1,1,0] op_sel_hi:[0,1,1] neg_lo:[0,1,0]
    v_pk_fma_f32 v[126:127], v[122:123], v[14:15], v[126:127] op_sel:[1,1,0] op_sel_hi:[0,1,1] neg_lo:[0,1,0]
    s_lshl_b32 s76, s6, 5
    s_lshl_b32 s77, s7, 2
    s_add_u32 s76, s76, s77
    s_add_u32 s76, s76, s10
    s_lshl_b32 s76, s76, 13
    s_add_u32 s76, s76, 0x400000
    v_cvt_pk_bf16_f32 v128, v64, v66
    v_cvt_pk_bf16_f32 v129, v96, v98
    v_cvt_pk_bf16_f32 v130, -v65, -v67
    v_cvt_pk_bf16_f32 v131, -v97, -v99
    v_cvt_pk_bf16_f32 v132, v68, v70
    v_cvt_pk_bf16_f32 v133, v100, v102
    v_cvt_pk_bf16_f32 v134, -v69, -v71
    v_cvt_pk_bf16_f32 v135, -v101, -v103
    v_cvt_pk_bf16_f32 v136, v72, v74
    v_cvt_pk_bf16_f32 v137, v104, v106
    v_cvt_pk_bf16_f32 v138, -v73, -v75
    v_cvt_pk_bf16_f32 v139, -v105, -v107
    v_cvt_pk_bf16_f32 v140, v76, v78
    v_cvt_pk_bf16_f32 v141, v108, v110
    v_cvt_pk_bf16_f32 v142, -v77, -v79
    v_cvt_pk_bf16_f32 v143, -v109, -v111
    v_cvt_pk_bf16_f32 v144, v80, v82
    v_cvt_pk_bf16_f32 v145, v112, v114
    v_cvt_pk_bf16_f32 v146, -v81, -v83
    v_cvt_pk_bf16_f32 v147, -v113, -v115
    v_cvt_pk_bf16_f32 v148, v84, v86
    v_cvt_pk_bf16_f32 v149, v116, v118
    v_cvt_pk_bf16_f32 v150, -v85, -v87
    v_cvt_pk_bf16_f32 v151, -v117, -v119
    v_cvt_pk_bf16_f32 v152, v88, v90
    v_cvt_pk_bf16_f32 v153, v120, v122
    v_cvt_pk_bf16_f32 v154, -v89, -v91
    v_cvt_pk_bf16_f32 v155, -v121, -v123
    v_cvt_pk_bf16_f32 v156, v92, v94
    v_cvt_pk_bf16_f32 v157, v124, v126
    v_cvt_pk_bf16_f32 v158, -v93, -v95
    v_cvt_pk_bf16_f32 v159, -v125, -v127
    v_permlane16_swap_b32 v128, v130
    v_permlane16_swap_b32 v129, v131
    v_permlane16_swap_b32 v132, v134
    v_permlane16_swap_b32 v133, v135
    v_permlane16_swap_b32 v136, v138
    v_permlane16_swap_b32 v137, v139
    v_permlane16_swap_b32 v140, v142
    v_permlane16_swap_b32 v141, v143
    v_permlane16_swap_b32 v144, v146
    v_permlane16_swap_b32 v145, v147
    v_permlane16_swap_b32 v148, v150
    v_permlane16_swap_b32 v149, v151
    v_permlane16_swap_b32 v152, v154
    v_permlane16_swap_b32 v153, v155
    v_permlane16_swap_b32 v156, v158
    v_permlane16_swap_b32 v157, v159
    s_lshl_b32 s15, s6, 8
    s_lshl_b32 s77, s7, 5
    s_add_u32 s15, s15, s77
    s_lshl_b32 s77, s10, 3
    s_add_u32 s15, s15, s77
    s_add_u32 s15, s15, 0x2000
    v_mov_b32 v4, s46
    v_mov_b32 v5, s47
    v_mov_b32 v6, 0
    s_cmp_eq_u32 s14, 1
    s_cbranch_scc0 L_Bh_slow
    buffer_store_dwordx4 v[128:131], v3, s[68:71], s76 offen offset:0 nt
    buffer_store_dwordx4 v[132:135], v3, s[68:71], s76 offen offset:1024 nt
    buffer_store_dwordx4 v[136:139], v3, s[68:71], s76 offen offset:2048 nt
    buffer_store_dwordx4 v[140:143], v3, s[68:71], s76 offen offset:3072 nt
    s_add_u32 s76, s76, 4096
    buffer_store_dwordx4 v[144:147], v3, s[68:71], s76 offen offset:0 nt
    buffer_store_dwordx4 v[148:151], v3, s[68:71], s76 offen offset:1024 nt
    buffer_store_dwordx4 v[152:155], v3, s[68:71], s76 offen offset:2048 nt
    buffer_store_dwordx4 v[156:159], v3, s[68:71], s76 offen offset:3072 nt
L_Bh_join:
    s_lshl_b32 s76, s10, 13
    s_add_u32 s76, s76, 131072
    v_add_u32 v7, s76, v3
    ds_write_b128 v7, v[128:131] offset:0
    ds_write_b128 v7, v[132:135] offset:1024
    ds_write_b128 v7, v[136:139] offset:2048
    ds_write_b128 v7, v[140:143] offset:3072
    ds_write_b128 v7, v[144:147] offset:4096
    ds_write_b128 v7, v[148:151] offset:5120
    ds_write_b128 v7, v[152:155] offset:6144
    ds_write_b128 v7, v[156:159] offset:7168
    s_cmp_eq_u32 s14, 1
    s_cbranch_scc0 L_Bf_slow
    s_waitcnt vmcnt(0)
    s_mov_b64 exec, 1
    buffer_store_dwordx2 v[4:5], v6, s[68:71], s15 offen nt
    s_mov_b64 exec, -1
L_Bf_join:
    s_add_u32 s76, s13, 0
    buffer_load_dwordx2 v[200:201], v226, s[48:51], s76 offen
    s_add_u32 s76, s13, 8192
    buffer_load_dwordx2 v[202:203], v226, s[48:51], s76 offen
    s_add_u32 s76, s13, 16384
    buffer_load_dwordx2 v[204:205], v226, s[48:51], s76 offen
    s_add_u32 s76, s13, 24576
    buffer_load_dwordx2 v[206:207], v226, s[48:51], s76 offen
    s_add_u32 s76, s13, 1024
    buffer_load_dwordx2 v[208:209], v226, s[48:51], s76 offen
    s_add_u32 s76, s13, 9216
    buffer_load_dwordx2 v[210:211], v226, s[48:51], s76 offen
    s_add_u32 s76, s13, 17408
    buffer_load_dwordx2 v[212:213], v226, s[48:51], s76 offen
    s_add_u32 s76, s13, 25600
    buffer_load_dwordx2 v[214:215], v226, s[48:51], s76 offen
    s_waitcnt lgkmcnt(0)
    s_barrier
    ds_read_b128 v[168:171], v224 offset:0
    ds_read_b128 v[172:175], v224 offset:1024
    v_xor_b32 v217, s16, v216
    ds_read_b128 v[40:43], v217 offset:0
    ds_read_b128 v[44:47], v217 offset:2048
    ds_read_b128 v[48:51], v217 offset:4096
    ds_read_b128 v[52:55], v217 offset:6144
    ds_read_b128 v[176:179], v224 offset:8192
    ds_read_b128 v[180:183], v224 offset:9216
    ds_read_b128 v[184:187], v224 offset:16384
    ds_read_b128 v[188:191], v224 offset:17408
    ds_read_b128 v[192:195], v224 offset:24576
    ds_read_b128 v[196:199], v224 offset:25600
    s_waitcnt lgkmcnt(0)
    v_mfma_f32_16x16x32_bf16 v[8:11], v[168:171], v[40:43], 0
    v_xor_b32 v218, s17, v216
    v_mfma_f32_16x16x32_bf16 v[12:15], v[168:171], v[44:47], 0
    ds_read_b128 v[56:59], v218 offset:0
    v_mfma_f32_16x16x32_bf16 v[16:19], v[168:171], v[48:51], 0
    ds_read_b128 v[60:63], v218 offset:2048
    v_mfma_f32_16x16x32_bf16 v[20:23], v[168:171], v[52:55], 0
    ds_read_b128 v[64:67], v218 offset:4096
    v_mfma_f32_16x16x32_bf16 v[24:27], v[172:175], v[40:43], 0
    ds_read_b128 v[68:71], v218 offset:6144
    v_mfma_f32_16x16x32_bf16 v[28:31], v[172:175], v[44:47], 0
    v_mfma_f32_16x16x32_bf16 v[32:35], v[172:175], v[48:51], 0
    v_mfma_f32_16x16x32_bf16 v[36:39], v[172:175], v[52:55], 0
    s_waitcnt lgkmcnt(0)
    v_mfma_f32_16x16x32_bf16 v[8:11], v[176:179], v[56:59], v[8:11]
    v_xor_b32 v217, s18, v216
    v_mfma_f32_16x16x32_bf16 v[12:15], v[176:179], v[60:63], v[12:15]
    ds_read_b128 v[40:43], v217 offset:0
    v_mfma_f32_16x16x32_bf16 v[16:19], v[176:179], v[64:67], v[16:19]
    ds_read_b128 v[44:47], v217 offset:2048
    v_mfma_f32_16x16x32_bf16 v[20:23], v[176:179], v[68:71], v[20:23]
    ds_read_b128 v[48:51], v217 offset:4096
    v_mfma_f32_16x16x32_bf16 v[24:27], v[180:183], v[56:59], v[24:27]
    ds_read_b128 v[52:55], v217 offset:6144
    v_mfma_f32_16x16x32_bf16 v[28:31], v[180:183], v[60:63], v[28:31]
    v_mfma_f32_16x16x32_bf16 v[32:35], v[180:183], v[64:67], v[32:35]
    v_mfma_f32_16x16x32_bf16 v[36:39], v[180:183], v[68:71], v[36:39]
    s_waitcnt lgkmcnt(0)
    v_mfma_f32_16x16x32_bf16 v[8:11], v[184:187], v[40:43], v[8:11]
    v_xor_b32 v218, s19, v216
    v_mfma_f32_16x16x32_bf16 v[12:15], v[184:187], v[44:47], v[12:15]
    ds_read_b128 v[56:59], v218 offset:0
    v_mfma_f32_16x16x32_bf16 v[16:19], v[184:187], v[48:51], v[16:19]
    ds_read_b128 v[60:63], v218 offset:2048
    v_mfma_f32_16x16x32_bf16 v[20:23], v[184:187], v[52:55], v[20:23]
    ds_read_b128 v[64:67], v218 offset:4096
    v_mfma_f32_16x16x32_bf16 v[24:27], v[188:191], v[40:43], v[24:27]
    ds_read_b128 v[68:71], v218 offset:6144
    v_mfma_f32_16x16x32_bf16 v[28:31], v[188:191], v[44:47], v[28:31]
    v_mfma_f32_16x16x32_bf16 v[32:35], v[188:191], v[48:51], v[32:35]
    v_mfma_f32_16x16x32_bf16 v[36:39], v[188:191], v[52:55], v[36:39]
    s_barrier
    s_lshl_b32 s78, s20, 8
    buffer_load_dwordx4 v[72:75], v219, s[68:71], s78 offen sc1
    buffer_load_dwordx4 v[76:79], v219, s[68:71], s78 offen offset:1024 sc1
    s_lshl_b32 s78, s21, 8
    buffer_load_dwordx4 v[80:83], v219, s[68:71], s78 offen sc1
    buffer_load_dwordx4 v[84:87], v219, s[68:71], s78 offen offset:1024 sc1
    s_lshl_b32 s78, s22, 8
    buffer_load_dwordx4 v[88:91], v219, s[68:71], s78 offen sc1
    buffer_load_dwordx4 v[92:95], v219, s[68:71], s78 offen offset:1024 sc1
    s_lshl_b32 s78, s23, 8
    buffer_load_dwordx4 v[96:99], v219, s[68:71], s78 offen sc1
    buffer_load_dwordx4 v[100:103], v219, s[68:71], s78 offen offset:1024 sc1
    s_lshl_b32 s78, s24, 8
    buffer_load_dwordx4 v[104:107], v219, s[68:71], s78 offen sc1
    buffer_load_dwordx4 v[108:111], v219, s[68:71], s78 offen offset:1024 sc1
    s_lshl_b32 s78, s25, 8
    buffer_load_dwordx4 v[112:115], v219, s[68:71], s78 offen sc1
    buffer_load_dwordx4 v[116:119], v219, s[68:71], s78 offen offset:1024 sc1
    s_lshl_b32 s78, s26, 8
    buffer_load_dwordx4 v[120:123], v219, s[68:71], s78 offen sc1
    buffer_load_dwordx4 v[124:127], v219, s[68:71], s78 offen offset:1024 sc1
    s_lshl_b32 s78, s27, 8
    buffer_load_dwordx4 v[128:131], v219, s[68:71], s78 offen sc1
    buffer_load_dwordx4 v[132:135], v219, s[68:71], s78 offen offset:1024 sc1
    s_lshl_b32 s78, s28, 8
    buffer_load_dwordx4 v[136:139], v219, s[68:71], s78 offen sc1
    buffer_load_dwordx4 v[140:143], v219, s[68:71], s78 offen offset:1024 sc1
    s_lshl_b32 s78, s29, 8
    buffer_load_dwordx4 v[144:147], v219, s[68:71], s78 offen sc1
    buffer_load_dwordx4 v[148:151], v219, s[68:71], s78 offen offset:1024 sc1
    s_lshl_b32 s78, s30, 8
    buffer_load_dwordx4 v[152:155], v219, s[68:71], s78 offen sc1
    buffer_load_dwordx4 v[156:159], v219, s[68:71], s78 offen offset:1024 sc1
    s_lshl_b32 s78, s31, 8
    buffer_load_dwordx4 v[160:163], v219, s[68:71], s78 offen sc1
    buffer_load_dwordx4 v[164:167], v219, s[68:71], s78 offen offset:1024 sc1
    s_waitcnt lgkmcnt(0)
    v_mfma_f32_16x16x32_bf16 v[8:11], v[192:195], v[56:59], v[8:11]
    v_xor_b32 v217, s20, v216
    v_mfma_f32_16x16x32_bf16 v[12:15], v[192:195], v[60:63], v[12:15]
    ds_read_b128 v[40:43], v217 offset:0
    v_mfma_f32_16x16x32_bf16 v[16:19], v[192:195], v[64:67], v[16:19]
    ds_read_b128 v[44:47], v217 offset:2048
    v_mfma_f32_16x16x32_bf16 v[20:23], v[192:195], v[68:71], v[20:23]
    ds_read_b128 v[48:51], v217 offset:4096
    v_mfma_f32_16x16x32_bf16 v[24:27], v[196:199], v[56:59], v[24:27]
    ds_read_b128 v[52:55], v217 offset:6144
    v_mfma_f32_16x16x32_bf16 v[28:31], v[196:199], v[60:63], v[28:31]
    v_mfma_f32_16x16x32_bf16 v[32:35], v[196:199], v[64:67], v[32:35]
    v_mfma_f32_16x16x32_bf16 v[36:39], v[196:199], v[68:71], v[36:39]
    s_waitcnt vmcnt(22) lgkmcnt(0)
    v_mfma_f32_16x16x32_bf16 v[8:11], v[72:75], v[40:43], v[8:11]
    v_xor_b32 v218, s21, v216
    v_mfma_f32_16x16x32_bf16 v[12:15], v[72:75], v[44:47], v[12:15]
    ds_read_b128 v[56:59], v218 offset:0
    v_mfma_f32_16x16x32_bf16 v[16:19], v[72:75], v[48:51], v[16:19]
    ds_read_b128 v[60:63], v218 offset:2048
    v_mfma_f32_16x16x32_bf16 v[20:23], v[72:75], v[52:55], v[20:23]
    ds_read_b128 v[64:67], v218 offset:4096
    v_mfma_f32_16x16x32_bf16 v[24:27], v[76:79], v[40:43], v[24:27]
    ds_read_b128 v[68:71], v218 offset:6144
    v_mfma_f32_16x16x32_bf16 v[28:31], v[76:79], v[44:47], v[28:31]
    s_lshl_b32 s78, s32, 8
    v_mfma_f32_16x16x32_bf16 v[32:35], v[76:79], v[48:51], v[32:35]
    buffer_load_dwordx4 v[168:171], v219, s[68:71], s78 offen sc1
    v_mfma_f32_16x16x32_bf16 v[36:39], v[76:79], v[52:55], v[36:39]
    buffer_load_dwordx4 v[172:175], v219, s[68:71], s78 offen offset:1024 sc1
    s_waitcnt vmcnt(22) lgkmcnt(0)
    v_mfma_f32_16x16x32_bf16 v[8:11], v[80:83], v[56:59], v[8:11]
    v_xor_b32 v217, s22, v216
    ds_read_b128 v[40:43], v217 offset:0
    v_mfma_f32_16x16x32_bf16 v[12:15], v[80:83], v[60:63], v[12:15]
    ds_read_b128 v[44:47], v217 offset:2048
    ds_read_b128 v[48:51], v217 offset:4096
    v_mfma_f32_16x16x32_bf16 v[16:19], v[80:83], v[64:67], v[16:19]
    ds_read_b128 v[52:55], v217 offset:6144
    s_lshl_b32 s78, s33, 8
    v_mfma_f32_16x16x32_bf16 v[20:23], v[80:83], v[68:71], v[20:23]
    buffer_load_dwordx4 v[176:179], v219, s[68:71], s78 offen sc1
    buffer_load_dwordx4 v[180:183], v219, s[68:71], s78 offen offset:1024 sc1
    v_mfma_f32_16x16x32_bf16 v[24:27], v[84:87], v[56:59], v[24:27]
    s_lshl_b32 s78, s34, 8
    buffer_load_dwordx4 v[184:187], v219, s[68:71], s78 offen sc1
    v_mfma_f32_16x16x32_bf16 v[28:31], v[84:87], v[60:63], v[28:31]
    buffer_load_dwordx4 v[188:191], v219, s[68:71], s78 offen offset:1024 sc1
    v_mfma_f32_16x16x32_bf16 v[32:35], v[84:87], v[64:67], v[32:35]
    v_mfma_f32_16x16x32_bf16 v[36:39], v[84:87], v[68:71], v[36:39]
    s_waitcnt vmcnt(24) lgkmcnt(0)
    v_mfma_f32_16x16x32_bf16 v[8:11], v[88:91], v[40:43], v[8:11]
    v_xor_b32 v218, s23, v216
    ds_read_b128 v[56:59], v218 offset:0
    v_mfma_f32_16x16x32_bf16 v[12:15], v[88:91], v[44:47], v[12:15]
    ds_read_b128 v[60:63], v218 offset:2048
    ds_read_b128 v[64:67], v218 offset:4096
    v_mfma_f32_16x16x32_bf16 v[16:19], v[88:91], v[48:51], v[16:19]
    ds_read_b128 v[68:71], v218 offset:6144
    s_lshl_b32 s78, s35, 8
    v_mfma_f32_16x16x32_bf16 v[20:23], v[88:91], v[52:55], v[20:23]
    buffer_load_dwordx4 v[192:195], v219, s[68:71], s78 offen sc1
    buffer_load_dwordx4 v[196:199], v219, s[68:71], s78 offen offset:1024 sc1
    v_mfma_f32_16x16x32_bf16 v[24:27], v[92:95], v[40:43], v[24:27]
    s_lshl_b32 s78, s36, 8
    buffer_load_dwordx4 v[72:75], v219, s[68:71], s78 offen sc1
    v_mfma_f32_16x16x32_bf16 v[28:31], v[92:95], v[44:47], v[28:31]
    buffer_load_dwordx4 v[76:79], v219, s[68:71], s78 offen offset:1024 sc1
    v_mfma_f32_16x16x32_bf16 v[32:35], v[92:95], v[48:51], v[32:35]
    v_mfma_f32_16x16x32_bf16 v[36:39], v[92:95], v[52:55], v[36:39]
    s_waitcnt vmcnt(26) lgkmcnt(0)
    v_mfma_f32_16x16x32_bf16 v[8:11], v[96:99], v[56:59], v[8:11]
    v_xor_b32 v217, s24, v216
    v_mfma_f32_16x16x32_bf16 v[12:15], v[96:99], v[60:63], v[12:15]
    ds_read_b128 v[40:43], v217 offset:0
    v_mfma_f32_16x16x32_bf16 v[16:19], v[96:99], v[64:67], v[16:19]
    ds_read_b128 v[44:47], v217 offset:2048
    v_mfma_f32_16x16x32_bf16 v[20:23], v[96:99], v[68:71], v[20:23]
    ds_read_b128 v[48:51], v217 offset:4096
    v_mfma_f32_16x16x32_bf16 v[24:27], v[100:103], v[56:59], v[24:27]
    ds_read_b128 v[52:55], v217 offset:6144
    v_mfma_f32_16x16x32_bf16 v[28:31], v[100:103], v[60:63], v[28:31]
    s_lshl_b32 s78, s37, 8
    v_mfma_f32_16x16x32_bf16 v[32:35], v[100:103], v[64:67], v[32:35]
    buffer_load_dwordx4 v[80:83], v219, s[68:71], s78 offen sc1
    v_mfma_f32_16x16x32_bf16 v[36:39], v[100:103], v[68:71], v[36:39]
    buffer_load_dwordx4 v[84:87], v219, s[68:71], s78 offen offset:1024 sc1
    s_waitcnt vmcnt(26) lgkmcnt(0)
    v_mfma_f32_16x16x32_bf16 v[8:11], v[104:107], v[40:43], v[8:11]
    v_xor_b32 v218, s25, v216
    v_mfma_f32_16x16x32_bf16 v[12:15], v[104:107], v[44:47], v[12:15]
    ds_read_b128 v[56:59], v218 offset:0
    v_mfma_f32_16x16x32_bf16 v[16:19], v[104:107], v[48:51], v[16:19]
    ds_read_b128 v[60:63], v218 offset:2048
    v_mfma_f32_16x16x32_bf16 v[20:23], v[104:107], v[52:55], v[20:23]
    ds_read_b128 v[64:67], v218 offset:4096
    v_mfma_f32_16x16x32_bf16 v[24:27], v[108:111], v[40:43], v[24:27]
    ds_read_b128 v[68:71], v218 offset:6144
    v_mfma_f32_16x16x32_bf16 v[28:31], v[108:111], v[44:47], v[28:31]
    s_lshl_b32 s78, s52, 8
    v_mfma_f32_16x16x32_bf16 v[32:35], v[108:111], v[48:51], v[32:35]
    buffer_load_dwordx4 v[88:91], v219, s[68:71], s78 offen sc1
    v_mfma_f32_16x16x32_bf16 v[36:39], v[108:111], v[52:55], v[36:39]
    buffer_load_dwordx4 v[92:95], v219, s[68:71], s78 offen offset:1024 sc1
    s_waitcnt vmcnt(26) lgkmcnt(0)
    v_mfma_f32_16x16x32_bf16 v[8:11], v[112:115], v[56:59], v[8:11]
    v_xor_b32 v217, s26, v216
    v_mfma_f32_16x16x32_bf16 v[12:15], v[112:115], v[60:63], v[12:15]
    ds_read_b128 v[40:43], v217 offset:0
    v_mfma_f32_16x16x32_bf16 v[16:19], v[112:115], v[64:67], v[16:19]
    ds_read_b128 v[44:47], v217 offset:2048
    v_mfma_f32_16x16x32_bf16 v[20:23], v[112:115], v[68:71], v[20:23]
    ds_read_b128 v[48:51], v217 offset:4096
    v_mfma_f32_16x16x32_bf16 v[24:27], v[116:119], v[56:59], v[24:27]
    ds_read_b128 v[52:55], v217 offset:6144
    v_mfma_f32_16x16x32_bf16 v[28:31], v[116:119], v[60:63], v[28:31]
    s_lshl_b32 s78, s53, 8
    v_mfma_f32_16x16x32_bf16 v[32:35], v[116:119], v[64:67], v[32:35]
    buffer_load_dwordx4 v[96:99], v219, s[68:71], s78 offen sc1
    v_mfma_f32_16x16x32_bf16 v[36:39], v[116:119], v[68:71], v[36:39]
    buffer_load_dwordx4 v[100:103], v219, s[68:71], s78 offen offset:1024 sc1
    s_waitcnt vmcnt(26) lgkmcnt(0)
    v_mfma_f32_16x16x32_bf16 v[8:11], v[120:123], v[40:43], v[8:11]
    v_xor_b32 v218, s27, v216
    v_mfma_f32_16x16x32_bf16 v[12:15], v[120:123], v[44:47], v[12:15]
    ds_read_b128 v[56:59], v218 offset:0
    v_mfma_f32_16x16x32_bf16 v[16:19], v[120:123], v[48:51], v[16:19]
    ds_read_b128 v[60:63], v218 offset:2048
    v_mfma_f32_16x16x32_bf16 v[20:23], v[120:123], v[52:55], v[20:23]
    ds_read_b128 v[64:67], v218 offset:4096
    v_mfma_f32_16x16x32_bf16 v[24:27], v[124:127], v[40:43], v[24:27]
    ds_read_b128 v[68:71], v218 offset:6144
    v_mfma_f32_16x16x32_bf16 v[28:31], v[124:127], v[44:47], v[28:31]
    s_lshl_b32 s78, s54, 8
    v_mfma_f32_16x16x32_bf16 v[32:35], v[124:127], v[48:51], v[32:35]
    buffer_load_dwordx4 v[104:107], v219, s[68:71], s78 offen sc1
    v_mfma_f32_16x16x32_bf16 v[36:39], v[124:127], v[52:55], v[36:39]
    buffer_load_dwordx4 v[108:111], v219, s[68:71], s78 offen offset:1024 sc1
    s_waitcnt vmcnt(26) lgkmcnt(0)
    v_mfma_f32_16x16x32_bf16 v[8:11], v[128:131], v[56:59], v[8:11]
    v_xor_b32 v217, s28, v216
    v_mfma_f32_16x16x32_bf16 v[12:15], v[128:131], v[60:63], v[12:15]
    ds_read_b128 v[40:43], v217 offset:0
    v_mfma_f32_16x16x32_bf16 v[16:19], v[128:131], v[64:67], v[16:19]
    ds_read_b128 v[44:47], v217 offset:2048
    v_mfma_f32_16x16x32_bf16 v[20:23], v[128:131], v[68:71], v[20:23]
    ds_read_b128 v[48:51], v217 offset:4096
    v_mfma_f32_16x16x32_bf16 v[24:27], v[132:135], v[56:59], v[24:27]
    ds_read_b128 v[52:55], v217 offset:6144
    v_mfma_f32_16x16x32_bf16 v[28:31], v[132:135], v[60:63], v[28:31]
    s_lshl_b32 s78, s55, 8
    v_mfma_f32_16x16x32_bf16 v[32:35], v[132:135], v[64:67], v[32:35]
    buffer_load_dwordx4 v[112:115], v219, s[68:71], s78 offen sc1
    v_mfma_f32_16x16x32_bf16 v[36:39], v[132:135], v[68:71], v[36:39]
    buffer_load_dwordx4 v[116:119], v219, s[68:71], s78 offen offset:1024 sc1
    s_waitcnt vmcnt(26) lgkmcnt(0)
    v_mfma_f32_16x16x32_bf16 v[8:11], v[136:139], v[40:43], v[8:11]
    v_xor_b32 v218, s29, v216
    v_mfma_f32_16x16x32_bf16 v[12:15], v[136:139], v[44:47], v[12:15]
    ds_read_b128 v[56:59], v218 offset:0
    v_mfma_f32_16x16x32_bf16 v[16:19], v[136:139], v[48:51], v[16:19]
    ds_read_b128 v[60:63], v218 offset:2048
    v_mfma_f32_16x16x32_bf16 v[20:23], v[136:139], v[52:55], v[20:23]
    ds_read_b128 v[64:67], v218 offset:4096
    v_mfma_f32_16x16x32_bf16 v[24:27], v[140:143], v[40:43], v[24:27]
    ds_read_b128 v[68:71], v218 offset:6144
    v_mfma_f32_16x16x32_bf16 v[28:31], v[140:143], v[44:47], v[28:31]
    s_lshl_b32 s78, s56, 8
    v_mfma_f32_16x16x32_bf16 v[32:35], v[140:143], v[48:51], v[32:35]
    buffer_load_dwordx4 v[120:123], v219, s[68:71], s78 offen sc1
    v_mfma_f32_16x16x32_bf16 v[36:39], v[140:143], v[52:55], v[36:39]
    buffer_load_dwordx4 v[124:127], v219, s[68:71], s78 offen offset:1024 sc1
    s_waitcnt vmcnt(26) lgkmcnt(0)
    v_mfma_f32_16x16x32_bf16 v[8:11], v[144:147], v[56:59], v[8:11]
    v_xor_b32 v217, s30, v216
    v_mfma_f32_16x16x32_bf16 v[12:15], v[144:147], v[60:63], v[12:15]
    ds_read_b128 v[40:43], v217 offset:0
    v_mfma_f32_16x16x32_bf16 v[16:19], v[144:147], v[64:67], v[16:19]
    ds_read_b128 v[44:47], v217 offset:2048
    v_mfma_f32_16x16x32_bf16 v[20:23], v[144:147], v[68:71], v[20:23]
    ds_read_b128 v[48:51], v217 offset:4096
    v_mfma_f32_16x16x32_bf16 v[24:27], v[148:151], v[56:59], v[24:27]
    ds_read_b128 v[52:55], v217 offset:6144
    v_mfma_f32_16x16x32_bf16 v[28:31], v[148:151], v[60:63], v[28:31]
    s_lshl_b32 s78, s57, 8
    v_mfma_f32_16x16x32_bf16 v[32:35], v[148:151], v[64:67], v[32:35]
    buffer_load_dwordx4 v[128:131], v219, s[68:71], s78 offen sc1
    v_mfma_f32_16x16x32_bf16 v[36:39], v[148:151], v[68:71], v[36:39]
    buffer_load_dwordx4 v[132:135], v219, s[68:71], s78 offen offset:1024 sc1
    s_waitcnt vmcnt(26) lgkmcnt(0)
    v_mfma_f32_16x16x32_bf16 v[8:11], v[152:155], v[40:43], v[8:11]
    v_xor_b32 v218, s31, v216
    v_mfma_f32_16x16x32_bf16 v[12:15], v[152:155], v[44:47], v[12:15]
    ds_read_b128 v[56:59], v218 offset:0
    v_mfma_f32_16x16x32_bf16 v[16:19], v[152:155], v[48:51], v[16:19]
    ds_read_b128 v[60:63], v218 offset:2048
    v_mfma_f32_16x16x32_bf16 v[20:23], v[152:155], v[52:55], v[20:23]
    ds_read_b128 v[64:67], v218 offset:4096
    v_mfma_f32_16x16x32_bf16 v[24:27], v[156:159], v[40:43], v[24:27]
    ds_read_b128 v[68:71], v218 offset:6144
    v_mfma_f32_16x16x32_bf16 v[28:31], v[156:159], v[44:47], v[28:31]
    s_lshl_b32 s78, s58, 8
    v_mfma_f32_16x16x32_bf16 v[32:35], v[156:159], v[48:51], v[32:35]
    buffer_load_dwordx4 v[136:139], v219, s[68:71], s78 offen sc1
    v_mfma_f32_16x16x32_bf16 v[36:39], v[156:159], v[52:55], v[36:39]
    buffer_load_dwordx4 v[140:143], v219, s[68:71], s78 offen offset:1024 sc1
    s_waitcnt vmcnt(26) lgkmcnt(0)
    v_mfma_f32_16x16x32_bf16 v[8:11], v[160:163], v[56:59], v[8:11]
    v_xor_b32 v217, s32, v216
    v_mfma_f32_16x16x32_bf16 v[12:15], v[160:163], v[60:63], v[12:15]
    ds_read_b128 v[40:43], v217 offset:0
    v_mfma_f32_16x16x32_bf16 v[16:19], v[160:163], v[64:67], v[16:19]
    ds_read_b128 v[44:47], v217 offset:2048
    v_mfma_f32_16x16x32_bf16 v[20:23], v[160:163], v[68:71], v[20:23]
    ds_read_b128 v[48:51], v217 offset:4096
    v_mfma_f32_16x16x32_bf16 v[24:27], v[164:167], v[56:59], v[24:27]
    ds_read_b128 v[52:55], v217 offset:6144
    v_mfma_f32_16x16x32_bf16 v[28:31], v[164:167], v[60:63], v[28:31]
    s_lshl_b32 s78, s59, 8
    v_mfma_f32_16x16x32_bf16 v[32:35], v[164:167], v[64:67], v[32:35]
    buffer_load_dwordx4 v[144:147], v219, s[68:71], s78 offen sc1
    v_mfma_f32_16x16x32_bf16 v[36:39], v[164:167], v[68:71], v[36:39]
    buffer_load_dwordx4 v[148:151], v219, s[68:71], s78 offen offset:1024 sc1
    s_waitcnt vmcnt(26) lgkmcnt(0)
    v_mfma_f32_16x16x32_bf16 v[8:11], v[168:171], v[40:43], v[8:11]
    v_xor_b32 v218, s33, v216
    v_mfma_f32_16x16x32_bf16 v[12:15], v[168:171], v[44:47], v[12:15]
    ds_read_b128 v[56:59], v218 offset:0
    v_mfma_f32_16x16x32_bf16 v[16:19], v[168:171], v[48:51], v[16:19]
    ds_read_b128 v[60:63], v218 offset:2048
    v_mfma_f32_16x16x32_bf16 v[20:23], v[168:171], v[52:55], v[20:23]
    ds_read_b128 v[64:67], v218 offset:4096
    v_mfma_f32_16x16x32_bf16 v[24:27], v[172:175], v[40:43], v[24:27]
    ds_read_b128 v[68:71], v218 offset:6144
    v_mfma_f32_16x16x32_bf16 v[28:31], v[172:175], v[44:47], v[28:31]
    s_lshl_b32 s78, s64, 8
    v_mfma_f32_16x16x32_bf16 v[32:35], v[172:175], v[48:51], v[32:35]
    buffer_load_dwordx4 v[152:155], v219, s[68:71], s78 offen sc1
    v_mfma_f32_16x16x32_bf16 v[36:39], v[172:175], v[52:55], v[36:39]
    buffer_load_dwordx4 v[156:159], v219, s[68:71], s78 offen offset:1024 sc1
    s_waitcnt vmcnt(26) lgkmcnt(0)
    v_mfma_f32_16x16x32_bf16 v[8:11], v[176:179], v[56:59], v[8:11]
    v_xor_b32 v217, s34, v216
    v_mfma_f32_16x16x32_bf16 v[12:15], v[176:179], v[60:63], v[12:15]
    ds_read_b128 v[40:43], v217 offset:0
    v_mfma_f32_16x16x32_bf16 v[16:19], v[176:179], v[64:67], v[16:19]
    ds_read_b128 v[44:47], v217 offset:2048
    v_mfma_f32_16x16x32_bf16 v[20:23], v[176:179], v[68:71], v[20:23]
    ds_read_b128 v[48:51], v217 offset:4096
    v_mfma_f32_16x16x32_bf16 v[24:27], v[180:183], v[56:59], v[24:27]
    ds_read_b128 v[52:55], v217 offset:6144
    v_mfma_f32_16x16x32_bf16 v[28:31], v[180:183], v[60:63], v[28:31]
    s_lshl_b32 s78, s65, 8
    v_mfma_f32_16x16x32_bf16 v[32:35], v[180:183], v[64:67], v[32:35]
    buffer_load_dwordx4 v[160:163], v219, s[68:71], s78 offen sc1
    v_mfma_f32_16x16x32_bf16 v[36:39], v[180:183], v[68:71], v[36:39]
    buffer_load_dwordx4 v[164:167], v219, s[68:71], s78 offen offset:1024 sc1
    s_waitcnt vmcnt(26) lgkmcnt(0)
    v_mfma_f32_16x16x32_bf16 v[8:11], v[184:187], v[40:43], v[8:11]
    v_xor_b32 v218, s35, v216
    v_mfma_f32_16x16x32_bf16 v[12:15], v[184:187], v[44:47], v[12:15]
    ds_read_b128 v[56:59], v218 offset:0
    v_mfma_f32_16x16x32_bf16 v[16:19], v[184:187], v[48:51], v[16:19]
    ds_read_b128 v[60:63], v218 offset:2048
    v_mfma_f32_16x16x32_bf16 v[20:23], v[184:187], v[52:55], v[20:23]
    ds_read_b128 v[64:67], v218 offset:4096
    v_mfma_f32_16x16x32_bf16 v[24:27], v[188:191], v[40:43], v[24:27]
    ds_read_b128 v[68:71], v218 offset:6144
    v_mfma_f32_16x16x32_bf16 v[28:31], v[188:191], v[44:47], v[28:31]
    v_mfma_f32_16x16x32_bf16 v[32:35], v[188:191], v[48:51], v[32:35]
    v_mfma_f32_16x16x32_bf16 v[36:39], v[188:191], v[52:55], v[36:39]
    s_waitcnt vmcnt(24) lgkmcnt(0)
    v_mfma_f32_16x16x32_bf16 v[8:11], v[192:195], v[56:59], v[8:11]
    v_xor_b32 v217, s36, v216
    v_mfma_f32_16x16x32_bf16 v[12:15], v[192:195], v[60:63], v[12:15]
    ds_read_b128 v[40:43], v217 offset:0
    v_mfma_f32_16x16x32_bf16 v[16:19], v[192:195], v[64:67], v[16:19]
    ds_read_b128 v[44:47], v217 offset:2048
    v_mfma_f32_16x16x32_bf16 v[20:23], v[192:195], v[68:71], v[20:23]
    ds_read_b128 v[48:51], v217 offset:4096
    v_mfma_f32_16x16x32_bf16 v[24:27], v[196:199], v[56:59], v[24:27]
    ds_read_b128 v[52:55], v217 offset:6144
    v_mfma_f32_16x16x32_bf16 v[28:31], v[196:199], v[60:63], v[28:31]
    v_mfma_f32_16x16x32_bf16 v[32:35], v[196:199], v[64:67], v[32:35]
    v_mfma_f32_16x16x32_bf16 v[36:39], v[196:199], v[68:71], v[36:39]
    s_waitcnt vmcnt(22) lgkmcnt(0)
    v_mfma_f32_16x16x32_bf16 v[8:11], v[72:75], v[40:43], v[8:11]
    v_xor_b32 v218, s37, v216
    v_mfma_f32_16x16x32_bf16 v[12:15], v[72:75], v[44:47], v[12:15]
    ds_read_b128 v[56:59], v218 offset:0
    v_mfma_f32_16x16x32_bf16 v[16:19], v[72:75], v[48:51], v[16:19]
    ds_read_b128 v[60:63], v218 offset:2048
    v_mfma_f32_16x16x32_bf16 v[20:23], v[72:75], v[52:55], v[20:23]
    ds_read_b128 v[64:67], v218 offset:4096
    v_mfma_f32_16x16x32_bf16 v[24:27], v[76:79], v[40:43], v[24:27]
    ds_read_b128 v[68:71], v218 offset:6144
    v_mfma_f32_16x16x32_bf16 v[28:31], v[76:79], v[44:47], v[28:31]
    v_mfma_f32_16x16x32_bf16 v[32:35], v[76:79], v[48:51], v[32:35]
    v_mfma_f32_16x16x32_bf16 v[36:39], v[76:79], v[52:55], v[36:39]
    s_waitcnt vmcnt(20) lgkmcnt(0)
    v_mfma_f32_16x16x32_bf16 v[8:11], v[80:83], v[56:59], v[8:11]
    v_xor_b32 v217, s52, v216
    v_mfma_f32_16x16x32_bf16 v[12:15], v[80:83], v[60:63], v[12:15]
    ds_read_b128 v[40:43], v217 offset:0
    v_mfma_f32_16x16x32_bf16 v[16:19], v[80:83], v[64:67], v[16:19]
    ds_read_b128 v[44:47], v217 offset:2048
    v_mfma_f32_16x16x32_bf16 v[20:23], v[80:83], v[68:71], v[20:23]
    ds_read_b128 v[48:51], v217 offset:4096
    v_mfma_f32_16x16x32_bf16 v[24:27], v[84:87], v[56:59], v[24:27]
    ds_read_b128 v[52:55], v217 offset:6144
    v_mfma_f32_16x16x32_bf16 v[28:31], v[84:87], v[60:63], v[28:31]
    v_mfma_f32_16x16x32_bf16 v[32:35], v[84:87], v[64:67], v[32:35]
    v_mfma_f32_16x16x32_bf16 v[36:39], v[84:87], v[68:71], v[36:39]
    s_waitcnt vmcnt(18) lgkmcnt(0)
    v_mfma_f32_16x16x32_bf16 v[8:11], v[88:91], v[40:43], v[8:11]
    v_xor_b32 v218, s53, v216
    v_mfma_f32_16x16x32_bf16 v[12:15], v[88:91], v[44:47], v[12:15]
    ds_read_b128 v[56:59], v218 offset:0
    v_mfma_f32_16x16x32_bf16 v[16:19], v[88:91], v[48:51], v[16:19]
    ds_read_b128 v[60:63], v218 offset:2048
    v_mfma_f32_16x16x32_bf16 v[20:23], v[88:91], v[52:55], v[20:23]
    ds_read_b128 v[64:67], v218 offset:4096
    v_mfma_f32_16x16x32_bf16 v[24:27], v[92:95], v[40:43], v[24:27]
    ds_read_b128 v[68:71], v218 offset:6144
    v_mfma_f32_16x16x32_bf16 v[28:31], v[92:95], v[44:47], v[28:31]
    v_mfma_f32_16x16x32_bf16 v[32:35], v[92:95], v[48:51], v[32:35]
    v_mfma_f32_16x16x32_bf16 v[36:39], v[92:95], v[52:55], v[36:39]
    s_waitcnt vmcnt(16) lgkmcnt(0)
    v_mfma_f32_16x16x32_bf16 v[8:11], v[96:99], v[56:59], v[8:11]
    v_xor_b32 v217, s54, v216
    v_mfma_f32_16x16x32_bf16 v[12:15], v[96:99], v[60:63], v[12:15]
    ds_read_b128 v[40:43], v217 offset:0
    v_mfma_f32_16x16x32_bf16 v[16:19], v[96:99], v[64:67], v[16:19]
    ds_read_b128 v[44:47], v217 offset:2048
    v_mfma_f32_16x16x32_bf16 v[20:23], v[96:99], v[68:71], v[20:23]
    ds_read_b128 v[48:51], v217 offset:4096
    v_mfma_f32_16x16x32_bf16 v[24:27], v[100:103], v[56:59], v[24:27]
    ds_read_b128 v[52:55], v217 offset:6144
    v_mfma_f32_16x16x32_bf16 v[28:31], v[100:103], v[60:63], v[28:31]
    v_mfma_f32_16x16x32_bf16 v[32:35], v[100:103], v[64:67], v[32:35]
    v_mfma_f32_16x16x32_bf16 v[36:39], v[100:103], v[68:71], v[36:39]
    s_waitcnt vmcnt(14) lgkmcnt(0)
    v_mfma_f32_16x16x32_bf16 v[8:11], v[104:107], v[40:43], v[8:11]
    v_xor_b32 v218, s55, v216
    v_mfma_f32_16x16x32_bf16 v[12:15], v[104:107], v[44:47], v[12:15]
    ds_read_b128 v[56:59], v218 offset:0
    v_mfma_f32_16x16x32_bf16 v[16:19], v[104:107], v[48:51], v[16:19]
    ds_read_b128 v[60:63], v218 offset:2048
    v_mfma_f32_16x16x32_bf16 v[20:23], v[104:107], v[52:55], v[20:23]
    ds_read_b128 v[64:67], v218 offset:4096
    v_mfma_f32_16x16x32_bf16 v[24:27], v[108:111], v[40:43], v[24:27]
    ds_read_b128 v[68:71], v218 offset:6144
    v_mfma_f32_16x16x32_bf16 v[28:31], v[108:111], v[44:47], v[28:31]
    v_mfma_f32_16x16x32_bf16 v[32:35], v[108:111], v[48:51], v[32:35]
    v_mfma_f32_16x16x32_bf16 v[36:39], v[108:111], v[52:55], v[36:39]
    s_waitcnt vmcnt(12) lgkmcnt(0)
    v_mfma_f32_16x16x32_bf16 v[8:11], v[112:115], v[56:59], v[8:11]
    v_xor_b32 v217, s56, v216
    v_mfma_f32_16x16x32_bf16 v[12:15], v[112:115], v[60:63], v[12:15]
    ds_read_b128 v[40:43], v217 offset:0
    v_mfma_f32_16x16x32_bf16 v[16:19], v[112:115], v[64:67], v[16:19]
    ds_read_b128 v[44:47], v217 offset:2048
    v_mfma_f32_16x16x32_bf16 v[20:23], v[112:115], v[68:71], v[20:23]
    ds_read_b128 v[48:51], v217 offset:4096
    v_mfma_f32_16x16x32_bf16 v[24:27], v[116:119], v[56:59], v[24:27]
    ds_read_b128 v[52:55], v217 offset:6144
    v_mfma_f32_16x16x32_bf16 v[28:31], v[116:119], v[60:63], v[28:31]
    v_mfma_f32_16x16x32_bf16 v[32:35], v[116:119], v[64:67], v[32:35]
    v_mfma_f32_16x16x32_bf16 v[36:39], v[116:119], v[68:71], v[36:39]
    s_waitcnt vmcnt(10) lgkmcnt(0)
    v_mfma_f32_16x16x32_bf16 v[8:11], v[120:123], v[40:43], v[8:11]
    v_xor_b32 v218, s57, v216
    v_mfma_f32_16x16x32_bf16 v[12:15], v[120:123], v[44:47], v[12:15]
    ds_read_b128 v[56:59], v218 offset:0
    v_mfma_f32_16x16x32_bf16 v[16:19], v[120:123], v[48:51], v[16:19]
    ds_read_b128 v[60:63], v218 offset:2048
    v_mfma_f32_16x16x32_bf16 v[20:23], v[120:123], v[52:55], v[20:23]
    ds_read_b128 v[64:67], v218 offset:4096
    v_mfma_f32_16x16x32_bf16 v[24:27], v[124:127], v[40:43], v[24:27]
    ds_read_b128 v[68:71], v218 offset:6144
    v_mfma_f32_16x16x32_bf16 v[28:31], v[124:127], v[44:47], v[28:31]
    v_mfma_f32_16x16x32_bf16 v[32:35], v[124:127], v[48:51], v[32:35]
    v_mfma_f32_16x16x32_bf16 v[36:39], v[124:127], v[52:55], v[36:39]
    s_waitcnt vmcnt(8) lgkmcnt(0)
    v_mfma_f32_16x16x32_bf16 v[8:11], v[128:131], v[56:59], v[8:11]
    v_xor_b32 v217, s58, v216
    v_mfma_f32_16x16x32_bf16 v[12:15], v[128:131], v[60:63], v[12:15]
    ds_read_b128 v[40:43], v217 offset:0
    v_mfma_f32_16x16x32_bf16 v[16:19], v[128:131], v[64:67], v[16:19]
    ds_read_b128 v[44:47], v217 offset:2048
    v_mfma_f32_16x16x32_bf16 v[20:23], v[128:131], v[68:71], v[20:23]
    ds_read_b128 v[48:51], v217 offset:4096
    v_mfma_f32_16x16x32_bf16 v[24:27], v[132:135], v[56:59], v[24:27]
    ds_read_b128 v[52:55], v217 offset:6144
    v_mfma_f32_16x16x32_bf16 v[28:31], v[132:135], v[60:63], v[28:31]
    v_mfma_f32_16x16x32_bf16 v[32:35], v[132:135], v[64:67], v[32:35]
    v_mfma_f32_16x16x32_bf16 v[36:39], v[132:135], v[68:71], v[36:39]
    s_waitcnt vmcnt(6) lgkmcnt(0)
    v_mfma_f32_16x16x32_bf16 v[8:11], v[136:139], v[40:43], v[8:11]
    v_xor_b32 v218, s59, v216
    v_mfma_f32_16x16x32_bf16 v[12:15], v[136:139], v[44:47], v[12:15]
    ds_read_b128 v[56:59], v218 offset:0
    v_mfma_f32_16x16x32_bf16 v[16:19], v[136:139], v[48:51], v[16:19]
    ds_read_b128 v[60:63], v218 offset:2048
    v_mfma_f32_16x16x32_bf16 v[20:23], v[136:139], v[52:55], v[20:23]
    ds_read_b128 v[64:67], v218 offset:4096
    v_mfma_f32_16x16x32_bf16 v[24:27], v[140:143], v[40:43], v[24:27]
    ds_read_b128 v[68:71], v218 offset:6144
    v_mfma_f32_16x16x32_bf16 v[28:31], v[140:143], v[44:47], v[28:31]
    v_mfma_f32_16x16x32_bf16 v[32:35], v[140:143], v[48:51], v[32:35]
    v_mfma_f32_16x16x32_bf16 v[36:39], v[140:143], v[52:55], v[36:39]
    s_waitcnt vmcnt(4) lgkmcnt(0)
    v_mfma_f32_16x16x32_bf16 v[8:11], v[144:147], v[56:59], v[8:11]
    v_xor_b32 v217, s64, v216
    v_mfma_f32_16x16x32_bf16 v[12:15], v[144:147], v[60:63], v[12:15]
    ds_read_b128 v[40:43], v217 offset:0
    v_mfma_f32_16x16x32_bf16 v[16:19], v[144:147], v[64:67], v[16:19]
    ds_read_b128 v[44:47], v217 offset:2048
    v_mfma_f32_16x16x32_bf16 v[20:23], v[144:147], v[68:71], v[20:23]
    ds_read_b128 v[48:51], v217 offset:4096
    v_mfma_f32_16x16x32_bf16 v[24:27], v[148:151], v[56:59], v[24:27]
    ds_read_b128 v[52:55], v217 offset:6144
    v_mfma_f32_16x16x32_bf16 v[28:31], v[148:151], v[60:63], v[28:31]
    v_mfma_f32_16x16x32_bf16 v[32:35], v[148:151], v[64:67], v[32:35]
    v_mfma_f32_16x16x32_bf16 v[36:39], v[148:151], v[68:71], v[36:39]
    s_waitcnt vmcnt(2) lgkmcnt(0)
    v_mfma_f32_16x16x32_bf16 v[8:11], v[152:155], v[40:43], v[8:11]
    v_xor_b32 v218, s65, v216
    v_mfma_f32_16x16x32_bf16 v[12:15], v[152:155], v[44:47], v[12:15]
    ds_read_b128 v[56:59], v218 offset:0
    v_mfma_f32_16x16x32_bf16 v[16:19], v[152:155], v[48:51], v[16:19]
    ds_read_b128 v[60:63], v218 offset:2048
    v_mfma_f32_16x16x32_bf16 v[20:23], v[152:155], v[52:55], v[20:23]
    ds_read_b128 v[64:67], v218 offset:4096
    v_mfma_f32_16x16x32_bf16 v[24:27], v[156:159], v[40:43], v[24:27]
    ds_read_b128 v[68:71], v218 offset:6144
    v_mfma_f32_16x16x32_bf16 v[28:31], v[156:159], v[44:47], v[28:31]
    v_mfma_f32_16x16x32_bf16 v[32:35], v[156:159], v[48:51], v[32:35]
    v_mfma_f32_16x16x32_bf16 v[36:39], v[156:159], v[52:55], v[36:39]
    s_waitcnt vmcnt(0) lgkmcnt(0)
    v_mfma_f32_16x16x32_bf16 v[8:11], v[160:163], v[56:59], v[8:11]
    v_mfma_f32_16x16x32_bf16 v[12:15], v[160:163], v[60:63], v[12:15]
    v_mfma_f32_16x16x32_bf16 v[16:19], v[160:163], v[64:67], v[16:19]
    v_mfma_f32_16x16x32_bf16 v[20:23], v[160:163], v[68:71], v[20:23]
    v_mfma_f32_16x16x32_bf16 v[24:27], v[164:167], v[56:59], v[24:27]
    v_mfma_f32_16x16x32_bf16 v[28:31], v[164:167], v[60:63], v[28:31]
    v_mfma_f32_16x16x32_bf16 v[32:35], v[164:167], v[64:67], v[32:35]
    v_mfma_f32_16x16x32_bf16 v[36:39], v[164:167], v[68:71], v[36:39]
    v_lshlrev_b32 v232, 16, v254
    v_and_b32 v233, 0xffff0000, v254
    v_lshlrev_b32 v234, 16, v255
    v_and_b32 v235, 0xffff0000, v255
    v_lshlrev_b32 v227, 17, v2
    v_lshl_add_u32 v227, v1, 4, v227
    s_lshl_b32 s13, s6, 19
    s_lshl_b32 s76, s10, 13
    s_add_u32 s13, s13, s76
    s_lshl_b32 s76, s7, 8
    s_add_u32 s13, s13, s76
    s_add_u32 s13, s13, 2048
    v_lshlrev_b32 v228, 16, v200
    v_and_b32 v229, 0xffff0000, v200
    v_lshlrev_b32 v230, 16, v201
    v_and_b32 v231, 0xffff0000, v201
    v_fma_f32 v72, v228, v232, v8
    v_fma_f32 v73, v229, v233, v12
    v_fma_f32 v74, v230, v234, v16
    v_fma_f32 v75, v231, v235, v20
    s_add_u32 s76, s13, 0
    buffer_store_dwordx4 v[72:75], v227, s[72:75], s76 offen nt
    v_lshlrev_b32 v228, 16, v202
    v_and_b32 v229, 0xffff0000, v202
    v_lshlrev_b32 v230, 16, v203
    v_and_b32 v231, 0xffff0000, v203
    v_fma_f32 v76, v228, v232, v9
    v_fma_f32 v77, v229, v233, v13
    v_fma_f32 v78, v230, v234, v17
    v_fma_f32 v79, v231, v235, v21
    s_add_u32 s76, s13, 32768
    buffer_store_dwordx4 v[76:79], v227, s[72:75], s76 offen nt
    v_lshlrev_b32 v228, 16, v204
    v_and_b32 v229, 0xffff0000, v204
    v_lshlrev_b32 v230, 16, v205
    v_and_b32 v231, 0xffff0000, v205
    v_fma_f32 v80, v228, v232, v10
    v_fma_f32 v81, v229, v233, v14
    v_fma_f32 v82, v230, v234, v18
    v_fma_f32 v83, v231, v235, v22
    s_add_u32 s76, s13, 65536
    buffer_store_dwordx4 v[80:83], v227, s[72:75], s76 offen nt
    v_lshlrev_b32 v228, 16, v206
    v_and_b32 v229, 0xffff0000, v206
    v_lshlrev_b32 v230, 16, v207
    v_and_b32 v231, 0xffff0000, v207
    v_fma_f32 v84, v228, v232, v11
    v_fma_f32 v85, v229, v233, v15
    v_fma_f32 v86, v230, v234, v19
    v_fma_f32 v87, v231, v235, v23
    s_add_u32 s76, s13, 98304
    buffer_store_dwordx4 v[84:87], v227, s[72:75], s76 offen nt
    v_lshlrev_b32 v228, 16, v208
    v_and_b32 v229, 0xffff0000, v208
    v_lshlrev_b32 v230, 16, v209
    v_and_b32 v231, 0xffff0000, v209
    v_fma_f32 v88, v228, v232, v24
    v_fma_f32 v89, v229, v233, v28
    v_fma_f32 v90, v230, v234, v32
    v_fma_f32 v91, v231, v235, v36
    s_add_u32 s76, s13, 4096
    buffer_store_dwordx4 v[88:91], v227, s[72:75], s76 offen nt
    v_lshlrev_b32 v228, 16, v210
    v_and_b32 v229, 0xffff0000, v210
    v_lshlrev_b32 v230, 16, v211
    v_and_b32 v231, 0xffff0000, v211
    v_fma_f32 v92, v228, v232, v25
    v_fma_f32 v93, v229, v233, v29
    v_fma_f32 v94, v230, v234, v33
    v_fma_f32 v95, v231, v235, v37
    s_add_u32 s76, s13, 36864
    buffer_store_dwordx4 v[92:95], v227, s[72:75], s76 offen nt
    v_lshlrev_b32 v228, 16, v212
    v_and_b32 v229, 0xffff0000, v212
    v_lshlrev_b32 v230, 16, v213
    v_and_b32 v231, 0xffff0000, v213
    v_fma_f32 v96, v228, v232, v26
    v_fma_f32 v97, v229, v233, v30
    v_fma_f32 v98, v230, v234, v34
    v_fma_f32 v99, v231, v235, v38
    s_add_u32 s76, s13, 69632
    buffer_store_dwordx4 v[96:99], v227, s[72:75], s76 offen nt
    v_lshlrev_b32 v228, 16, v214
    v_and_b32 v229, 0xffff0000, v214
    v_lshlrev_b32 v230, 16, v215
    v_and_b32 v231, 0xffff0000, v215
    v_fma_f32 v100, v228, v232, v27
    v_fma_f32 v101, v229, v233, v31
    v_fma_f32 v102, v230, v234, v35
    v_fma_f32 v103, v231, v235, v39
    s_add_u32 s76, s13, 102400
    buffer_store_dwordx4 v[100:103], v227, s[72:75], s76 offen nt
    s_endpgm
L_Ao_slow:
    buffer_store_dwordx4 v[40:43], v3, s[68:71], s76 offen offset:0 sc1
    buffer_store_dwordx4 v[48:51], v3, s[68:71], s76 offen offset:1024 sc1
    s_add_u32 s76, s76, 8192
    buffer_store_dwordx4 v[44:47], v3, s[68:71], s76 offen offset:0 sc1
    buffer_store_dwordx4 v[52:55], v3, s[68:71], s76 offen offset:1024 sc1
    s_branch L_Ao_join
L_Af_slow:
    s_waitcnt vmcnt(0)
    s_mov_b64 exec, 1
    buffer_store_dwordx2 v[4:5], v6, s[68:71], s15 offen sc1
    s_mov_b64 exec, -1
    s_branch L_Af_join
L_Bh_slow:
    buffer_store_dwordx4 v[128:131], v3, s[68:71], s76 offen offset:0 sc1
    buffer_store_dwordx4 v[132:135], v3, s[68:71], s76 offen offset:1024 sc1
    buffer_store_dwordx4 v[136:139], v3, s[68:71], s76 offen offset:2048 sc1
    buffer_store_dwordx4 v[140:143], v3, s[68:71], s76 offen offset:3072 sc1
    s_add_u32 s76, s76, 4096
    buffer_store_dwordx4 v[144:147], v3, s[68:71], s76 offen offset:0 sc1
    buffer_store_dwordx4 v[148:151], v3, s[68:71], s76 offen offset:1024 sc1
    buffer_store_dwordx4 v[152:155], v3, s[68:71], s76 offen offset:2048 sc1
    buffer_store_dwordx4 v[156:159], v3, s[68:71], s76 offen offset:3072 sc1
    s_branch L_Bh_join
L_Bf_slow:
    s_waitcnt vmcnt(0)
    s_mov_b64 exec, 1
    buffer_store_dwordx2 v[4:5], v6, s[68:71], s15 offen sc1
    s_mov_b64 exec, -1
    s_branch L_Bf_join
L_exit:
    s_endpgm
L_code_end:
    s_endpgm

.section .rodata,"a"
.p2align 6
.amdhsa_kernel concat_heads__linear_attn_block__ssm_conv_s5__prompt_kernel
  .amdhsa_next_free_vgpr 256
  .amdhsa_next_free_sgpr 102
  .amdhsa_accum_offset 256
  .amdhsa_group_segment_fixed_size 0
  .amdhsa_kernarg_size 120
  .amdhsa_user_sgpr_count 2
  .amdhsa_user_sgpr_kernarg_segment_ptr 1
  .amdhsa_system_sgpr_workgroup_id_x 1
.end_amdhsa_kernel
```
